```python
import torch

def _softmax(x, axis=-1):
    return torch.softmax(x, dim=axis)
def _gelu(x):
    return torch.nn.functional.gelu(x, approximate="tanh")
def _silu(x):
    return torch.nn.functional.silu(x)
def _sigmoid(x):
    return torch.sigmoid(x)
def _layernorm(x, axis=-1, eps=1e-5):
    m = x.mean(dim=axis, keepdim=True)
    v = x.var(dim=axis, keepdim=True, unbiased=False)
    return (x - m) / torch.sqrt(v + eps)
def _scatter_add(tgt, idx, src, axis=0):
    return tgt.clone().index_add_(axis, idx, src)
def _segment_sum(src, seg, n):
    out = torch.zeros((n,) + src.shape[1:], dtype=src.dtype)
    return out.index_add_(0, seg, src)
def _pad(x, pw):
    flat = tuple(v for pair in reversed(pw) for v in pair)
    return torch.nn.functional.pad(x, flat)

kernel_name = 'interleave_layers__softmax_full_mha__sliding_local_dilated__prompt'

def setup_inputs():

    _w = (lambda a: (lambda t: t.to(torch.bfloat16) if t.is_floating_point() else t)(torch.as_tensor(a)))
    def _A_setup():
        B, S, D = 1, 2048, 640
        return {
            "x": _w((lambda *s: torch.randn(*s, dtype=torch.bfloat16) * 0.05)(B, S, D)),
            "wqkv": _w((lambda *s: torch.randn(*s, dtype=torch.bfloat16) * 0.05)(D, 3 * D)),
            "wo": _w((lambda *s: torch.randn(*s, dtype=torch.bfloat16) * 0.05)(D, D)),
        }
    _A_in = _A_setup()

    def _B_setup():
        B, S, D = 1, 2048, 640
        return {
            "x": _w((lambda *s: torch.randn(*s, dtype=torch.bfloat16) * 0.05)(B, S, D)),
            "wqkv": _w((lambda *s: torch.randn(*s, dtype=torch.bfloat16) * 0.05)(D, 3 * D)),
            "wo": _w((lambda *s: torch.randn(*s, dtype=torch.bfloat16) * 0.05)(D, D)),
        }
    _B_in = _B_setup()

    return {
        "A_x": _A_in["x"],
        "A_wqkv": _A_in["wqkv"],
        "A_wo": _A_in["wo"],
        "B_x": _B_in["x"],
        "B_wqkv": _B_in["wqkv"],
        "B_wo": _B_in["wo"],
    }

def reference(A_x, A_wqkv, A_wo, B_x, B_wqkv, B_wo):
    def _A_ref(x, wqkv, wo):
        B, S, D = x.shape
        H = 32; Dh = D // H
        qkv = (lambda x, *d: x.permute(*d))((x @ wqkv).reshape(B, S, 3, H, Dh), 2, 0, 3, 1, 4)
        q, k, v = qkv[0], qkv[1], qkv[2]
        scale = Dh ** -0.5
        scores = torch.einsum("bhqd,bhkd->bhqk", q, k) * scale
        p = _softmax(scores, axis=-1)
        o = torch.einsum("bhqk,bhkd->bhqd", p, v)
        return (lambda x, *d: x.permute(*d))(o, 0, 2, 1, 3).reshape(B, S, D) @ wo

    def _B_ref(x, wqkv, wo):
        B, S, D = x.shape
        H = 32; Dh = D // H
        W, dil = 8, 2
        qkv = (lambda x, *d: x.permute(*d))((x @ wqkv).reshape(B, S, 3, H, Dh), 2, 0, 3, 1, 4)
        q, k, v = qkv[0], qkv[1], qkv[2]
        scale = Dh ** -0.5
        pos = torch.arange(S)
        off = torch.arange(W) * dil
        idx = pos[:, None] - off[None, :]
        mask = idx >= 0
        idx_c = torch.where(mask, idx, 0).reshape(-1)
        kg = k[:, :, idx_c, :].reshape(B, H, S, W, Dh)
        vg = v[:, :, idx_c, :].reshape(B, H, S, W, Dh)
        logits = torch.einsum("bhsd,bhswd->bhsw", q, kg) * scale
        logits = torch.where(mask[None, None, :, :], logits, -1e9)
        attn = _softmax(logits, axis=-1)
        o = torch.einsum("bhsw,bhswd->bhsd", attn, vg)
        return (lambda x, *d: x.permute(*d))(o, 0, 2, 1, 3).reshape(B, S, D) @ wo

    x = A_x
    x = x + _A_ref(_layernorm(x, axis=-1), A_wqkv, A_wo)
    x = x + _B_ref(_layernorm(x, axis=-1), B_wqkv, B_wo)
    x = x + _A_ref(_layernorm(x, axis=-1), A_wqkv, A_wo)
    x = x + _B_ref(_layernorm(x, axis=-1), B_wqkv, B_wo)
    return x
```

```asm
; @launch grid=(256,1,1) block=(640,1,1) lds=163840
.amdgcn_target "amdgcn-amd-amdhsa--gfx950"
.text
.globl interleave_layers__softmax_full_mha__sliding_local_dilated__prompt_kernel
.p2align 8
.type interleave_layers__softmax_full_mha__sliding_local_dilated__prompt_kernel,@function
interleave_layers__softmax_full_mha__sliding_local_dilated__prompt_kernel:
    s_load_dwordx2 s[62:63], s[0:1], 0
    s_load_dwordx2 s[8:9], s[0:1], 8
    s_load_dwordx2 s[4:5], s[0:1], 64
    s_load_dwordx2 s[100:101], s[0:1], 48
    s_cmp_ge_u32 s2, 256
    s_cbranch_scc1 L_exit
    v_lshrrev_b32 v1, 6, v0
    v_and_b32 v0, 63, v0
    v_readfirstlane_b32 s3, v1
    s_mov_b32 s6, 41820160
    s_mov_b32 s7, 0x20000
    s_mov_b32 s92, 0
    s_cmp_ge_u32 s2, 240
    s_cbranch_scc1 L_p0_idle
    s_and_b32 s28, s2, 7
    s_lshr_b32 s29, s2, 3
    s_and_b32 s30, s28, 1
    s_mul_i32 s30, s30, 30
    s_add_u32 s29, s29, s30
    s_lshr_b32 s20, s28, 1
    s_lshl_b32 s20, s20, 2
    s_and_b32 s30, s29, 3
    s_add_u32 s20, s20, s30
    s_lshr_b32 s21, s29, 2
    s_cmp_lt_u32 s3, 4
    s_cbranch_scc1 L_p0_comp
    s_cmp_ge_u32 s3, 8
    s_cbranch_scc1 L_p0_help
    s_mov_b32 s14, 2621440
    s_mov_b32 s15, 0x20000
    s_mov_b32 s10, 2457600
    s_mov_b32 s11, 0x20000
    s_sub_u32 s22, s3, 4
    s_lshl_b32 s28, s20, 7
    s_lshl_b32 s29, s22, 5
    s_add_u32 s28, s28, s29
    v_lshrrev_b32 v1, 3, v0
    v_add_u32 v1, s28, v1
    v_mul_u32_u24 v1, 1280, v1
    v_and_b32 v2, 7, v0
    v_lshrrev_b32 v3, 4, v0
    v_xor_b32 v2, v2, v3
    v_lshlrev_b32 v2, 4, v2
    v_xor_b32 v4, 64, v2
    v_add_u32 v10, v1, v2
    v_add_u32 v11, v1, v4
    v_add_u32 v11, 9216, v11
    v_add_u32 v12, 18432, v10
    v_add_u32 v13, 18432, v11
    s_mov_b32 s24, 0
    s_lshl_b32 s26, s22, 12
    s_mov_b32 m0, s26
    s_mov_b32 s31, 0
    s_waitcnt lgkmcnt(0)
    s_mov_b32 s12, s62
    s_mov_b32 s13, s63
    buffer_load_dwordx4 v10, s[12:15], s24 offen offset:0 lds
    buffer_load_dwordx4 v11, s[12:15], s24 offen offset:1024 lds
    buffer_load_dwordx4 v12, s[12:15], s24 offen offset:2048 lds
    buffer_load_dwordx4 v13, s[12:15], s24 offen offset:3072 lds
    s_lshl_b32 s28, s22, 4
    v_add_u32 v1, s28, v3
    v_mul_u32_u24 v1, 3840, v1
    s_lshl_b32 s25, s21, 8
    v_and_b32 v2, 15, v0
    v_lshlrev_b32 v4, 1, v3
    v_xor_b32 v4, v2, v4
    v_lshlrev_b32 v4, 4, v4
    v_add_u32 v14, v4, v1
    v_xor_b32 v4, 128, v4
    v_add_u32 v16, v4, v1
    v_add_u32 v15, 14336, v14
    v_add_u32 v16, 28672, v16
    v_add_u32 v17, 14336, v16
    s_mov_b32 s23, 0
    s_branch L_p0_ld_w
L_p0_ld_loop:
    s_add_u32 m0, s31, s26
    s_nop 0
    buffer_load_dwordx4 v10, s[12:15], s24 offen offset:0 lds
    buffer_load_dwordx4 v11, s[12:15], s24 offen offset:1024 lds
    buffer_load_dwordx4 v12, s[12:15], s24 offen offset:2048 lds
    buffer_load_dwordx4 v13, s[12:15], s24 offen offset:3072 lds
L_p0_ld_w:
    s_add_u32 m0, m0, 16384
    s_nop 0
    buffer_load_dwordx4 v14, s[8:11], s25 offen offset:0 lds
    buffer_load_dwordx4 v15, s[8:11], s25 offen offset:1024 lds
    buffer_load_dwordx4 v16, s[8:11], s25 offen offset:2048 lds
    buffer_load_dwordx4 v17, s[8:11], s25 offen offset:3072 lds
    s_add_u32 s24, s24, 128
    s_add_u32 s25, s25, 245760
    s_add_u32 s31, s31, 32768
    s_cmp_eq_u32 s31, 131072
    s_cselect_b32 s31, 0, s31
    s_add_u32 s23, s23, 1
    s_cmp_eq_u32 s23, 1
    s_cbranch_scc1 L_p0_ld_loop
    s_waitcnt vmcnt(8)
    s_barrier
    s_cmp_lt_u32 s23, 10
    s_cbranch_scc1 L_p0_ld_loop
    s_waitcnt vmcnt(0)
    s_barrier
    s_barrier
    s_barrier
    s_branch L_at
L_p0_help:
    s_cmp_eq_u32 s3, 9
    s_cbranch_scc0 L_p0_wc0
    s_getpc_b64 s[44:45]
L_p0_pc:
    s_mov_b32 s46, L_code_end - L_p0_pc
    s_mov_b32 s47, 0x20000
    v_lshlrev_b32 v6, 7, v0
    s_mov_b32 s24, 0
L_p0_wl:
    buffer_load_dword v7, v6, s[44:47], s24 offen
    s_add_u32 s24, s24, 8192
    s_cmp_lt_u32 s24, s46
    s_cbranch_scc1 L_p0_wl
L_p0_wc0:
    s_load_dwordx2 s[48:49], s[0:1], 56
    s_mov_b32 s50, 256
    s_mov_b32 s51, 0x20000
    v_mov_b32 v4, 0
    s_mov_b32 s61, 0
    s_waitcnt lgkmcnt(0)
    s_barrier
    s_barrier
    s_barrier
    s_barrier
    s_barrier
    buffer_load_dword v5, v4, s[48:51], 0 offen sc1
    s_barrier
    s_barrier
    s_barrier
    s_barrier
    s_barrier
    s_barrier
    s_branch L_p0_wc_1
L_p0_wc:
    buffer_load_dword v5, v4, s[48:51], 0 offen sc1
L_p0_wc_1:
    s_waitcnt vmcnt(0)
    v_readfirstlane_b32 s60, v5
    s_add_u32 s61, s61, 1
    s_cmp_ge_u32 s60, 16
    s_cbranch_scc1 L_p0_wc_ok
    s_sleep 4
    s_cmp_lt_u32 s61, 200000
    s_cbranch_scc1 L_p0_wc
L_p0_wc_ok:
    s_barrier
    s_branch L_at
L_p0_idle:
    s_load_dwordx2 s[48:49], s[0:1], 56
    s_sub_u32 s28, s2, 240
    s_mul_i32 s28, s28, 10
    s_add_u32 s28, s28, s3
    s_lshl_b32 s28, s28, 10
    v_lshlrev_b32 v4, 4, v0
    v_mov_b64 v[8:9], 0
    v_mov_b64 v[10:11], 0
    s_mov_b32 s50, 256
    s_mov_b32 s51, 0x20000
    s_cmp_lt_u32 s28, 139264
    s_waitcnt lgkmcnt(0)
    s_cbranch_scc0 L_p0_i1
    buffer_store_dwordx4 v[8:11], v4, s[4:7], s28 offen sc1
    s_waitcnt vmcnt(0)
L_p0_i1:
    s_barrier
    s_cmp_ge_u32 s3, 8
    s_cbranch_scc0 L_at
    s_cmp_eq_u32 s3, 8
    s_cbranch_scc0 L_p0_i2
    v_mov_b32 v6, 1
    s_mov_b64 exec, 1
    buffer_atomic_add v6, v8, s[48:51], 0 offen sc1
    s_mov_b64 exec, -1
L_p0_i2:
    s_load_dwordx2 s[48:49], s[0:1], 56
    s_mov_b32 s50, 256
    s_mov_b32 s51, 0x20000
    v_mov_b32 v4, 0
    s_mov_b32 s61, 0
    s_waitcnt lgkmcnt(0)
L_p0_wc2:
    buffer_load_dword v5, v4, s[48:51], 0 offen sc1
L_p0_wc2_1:
    s_waitcnt vmcnt(0)
    v_readfirstlane_b32 s60, v5
    s_add_u32 s61, s61, 1
    s_cmp_ge_u32 s60, 16
    s_cbranch_scc1 L_p0_wc2_ok
    s_sleep 4
    s_cmp_lt_u32 s61, 200000
    s_cbranch_scc1 L_p0_wc2
L_p0_wc2_ok:
    s_branch L_at
L_p0_comp:
    s_cmp_ge_u32 s21, 10
    s_cbranch_scc1 L_p0_v
    v_and_b32 v1, 15, v0
    v_lshrrev_b32 v2, 4, v0
    v_lshrrev_b32 v16, 1, v1
    v_xor_b32 v16, v16, v2
    v_lshlrev_b32 v16, 4, v16
    v_lshl_add_u32 v16, v1, 7, v16
    s_lshr_b32 s36, s3, 1
    s_and_b32 s37, s3, 1
    s_lshl_b32 s28, s37, 2
    s_lshl_b32 s29, s36, 1
    s_add_u32 s38, s28, s29
    s_add_u32 s39, s38, 1
    s_xor_b32 s40, s38, 2
    s_xor_b32 s41, s39, 2
    s_lshl_b32 s42, s36, 6
    s_lshl_b32 s28, s37, 5
    s_add_u32 s42, s42, s28
    s_xor_b32 s43, s42, 32
    s_lshl_b32 s28, s42, 7
    s_lshl_b32 s29, s43, 7
    v_add_u32 v3, s28, v16
    v_add_u32 v4, s29, v16
    v_xor_b32 v5, 64, v3
    v_xor_b32 v6, 64, v4
    v_lshrrev_b32 v17, 2, v1
    v_lshl_add_u32 v18, v2, 3, v17
    v_lshlrev_b32 v18, 8, v18
    v_and_b32 v19, 1, v2
    v_lshl_or_b32 v17, v19, 2, v17
    v_and_b32 v19, 3, v1
    v_lshl_add_u32 v18, v19, 3, v18
    v_add_u32 v18, 16384, v18
    v_xor_b32 v19, s38, v17
    v_lshl_add_u32 v7, v19, 5, v18
    v_mov_b32 v136, 1065369472
    v_xor_b32 v19, s39, v17
    v_lshl_add_u32 v8, v19, 5, v18
    v_mov_b32 v137, 1065369472
    v_xor_b32 v19, s40, v17
    v_lshl_add_u32 v9, v19, 5, v18
    v_mov_b32 v138, 1065369472
    v_xor_b32 v19, s41, v17
    v_lshl_add_u32 v10, v19, 5, v18
    v_mov_b32 v139, 1065369472
    s_cmp_ge_u32 s21, 5
    s_cselect_b32 s46, 1, 0
    s_mul_i32 s28, s46, 5
    s_sub_u32 s44, s21, s28
    s_lshl_b32 s45, s44, 1
    s_add_u32 s45, s45, s37
    s_lshl_b32 s29, s20, 2
    s_lshl_b32 s47, 1280, s46
    s_lshr_b32 s28, s42, 5
    s_add_u32 s28, s28, s29
    s_mul_i32 s30, s28, s47
    s_add_u32 s30, s30, 7741440
    s_lshr_b32 s28, s43, 5
    s_add_u32 s28, s28, s29
    s_mul_i32 s31, s28, s47
    s_add_u32 s31, s31, 7741440
    v_lshlrev_b32 v20, 4, v1
    s_lshl_b32 s48, 81920, s46
    s_cmp_eq_u32 s46, 1
    s_cselect_b32 s33, 2621440, 0
    s_cselect_b32 s49, 1.0, 0x3ea52b5c
    s_lshl_b32 s44, s44, 5
    s_lshl_b32 s28, s38, 2
    s_add_u32 s28, s28, s44
    v_add_u32 v17, s28, v2
    v_mul_u32_u24 v16, 205, v17
    v_lshrrev_b32 v16, 10, v16
    v_mad_i32_i24 v17, v16, -5, v17
    v_mul_u32_u24 v21, s48, v16
    v_bfe_u32 v18, v17, 1, 1
    v_and_b32 v19, 1, v17
    v_lshl_or_b32 v18, v19, 1, v18
    v_and_b32 v19, 4, v17
    v_or_b32 v18, v18, v19
    v_lshl_add_u32 v21, v18, 8, v21
    v_add3_u32 v11, v21, v20, s33
    s_lshl_b32 s28, s39, 2
    s_add_u32 s28, s28, s44
    v_add_u32 v17, s28, v2
    v_mul_u32_u24 v16, 205, v17
    v_lshrrev_b32 v16, 10, v16
    v_mad_i32_i24 v17, v16, -5, v17
    v_mul_u32_u24 v21, s48, v16
    v_bfe_u32 v18, v17, 1, 1
    v_and_b32 v19, 1, v17
    v_lshl_or_b32 v18, v19, 1, v18
    v_and_b32 v19, 4, v17
    v_or_b32 v18, v18, v19
    v_lshl_add_u32 v21, v18, 8, v21
    v_add3_u32 v12, v21, v20, s33
    s_lshl_b32 s28, s40, 2
    s_add_u32 s28, s28, s44
    v_add_u32 v17, s28, v2
    v_mul_u32_u24 v16, 205, v17
    v_lshrrev_b32 v16, 10, v16
    v_mad_i32_i24 v17, v16, -5, v17
    v_mul_u32_u24 v21, s48, v16
    v_bfe_u32 v18, v17, 1, 1
    v_and_b32 v19, 1, v17
    v_lshl_or_b32 v18, v19, 1, v18
    v_and_b32 v19, 4, v17
    v_or_b32 v18, v18, v19
    v_lshl_add_u32 v21, v18, 8, v21
    v_add3_u32 v13, v21, v20, s33
    s_lshl_b32 s28, s41, 2
    s_add_u32 s28, s28, s44
    v_add_u32 v17, s28, v2
    v_mul_u32_u24 v16, 205, v17
    v_lshrrev_b32 v16, 10, v16
    v_mad_i32_i24 v17, v16, -5, v17
    v_mul_u32_u24 v21, s48, v16
    v_bfe_u32 v18, v17, 1, 1
    v_and_b32 v19, 1, v17
    v_lshl_or_b32 v18, v19, 1, v18
    v_and_b32 v19, 4, v17
    v_or_b32 v18, v18, v19
    v_lshl_add_u32 v21, v18, 8, v21
    v_add3_u32 v14, v21, v20, s33
    s_mov_b32 s23, 0
    s_mov_b32 s27, 32768
    s_waitcnt lgkmcnt(0)
    s_barrier
    ds_read_b128 v[88:91], v3 offset:0
    ds_read_b128 v[92:95], v3 offset:2048
    ds_read_b128 v[96:99], v4 offset:0
    ds_read_b128 v[100:103], v4 offset:2048
    ds_read_b64_tr_b16 v[120:121], v7 offset:0
    ds_read_b64_tr_b16 v[122:123], v7 offset:1024
    ds_read_b64_tr_b16 v[124:125], v8 offset:0
    ds_read_b64_tr_b16 v[126:127], v8 offset:1024
    ds_read_b64_tr_b16 v[128:129], v9 offset:0
    ds_read_b64_tr_b16 v[130:131], v9 offset:1024
    ds_read_b64_tr_b16 v[132:133], v10 offset:0
    ds_read_b64_tr_b16 v[134:135], v10 offset:1024
    s_waitcnt lgkmcnt(6)
    v_mfma_f32_16x16x32_bf16 v[16:19], v[120:123], v[88:91], 0
    ds_read_b128 v[104:107], v5 offset:0
    v_mfma_f32_16x16x32_bf16 v[32:35], v[120:123], v[92:95], 0
    ds_read_b128 v[108:111], v5 offset:2048
    v_mfma_f32_16x16x32_bf16 v[48:51], v[120:123], v[96:99], 0
    v_add_u32 v3, s27, v3
    v_mfma_f32_16x16x32_bf16 v[64:67], v[120:123], v[100:103], 0
    v_mfma_f32_16x16x32_bf16 v[80:83], v[120:123], v[136:139], 0
    s_waitcnt lgkmcnt(6)
    v_mfma_f32_16x16x32_bf16 v[20:23], v[124:127], v[88:91], 0
    ds_read_b64_tr_b16 v[120:121], v7 offset:8192
    v_mfma_f32_16x16x32_bf16 v[36:39], v[124:127], v[92:95], 0
    ds_read_b64_tr_b16 v[122:123], v7 offset:9216
    v_mfma_f32_16x16x32_bf16 v[52:55], v[124:127], v[96:99], 0
    ds_read_b128 v[112:115], v6 offset:0
    v_mfma_f32_16x16x32_bf16 v[68:71], v[124:127], v[100:103], 0
    v_add_u32 v4, s27, v4
    v_mfma_f32_16x16x32_bf16 v[84:87], v[124:127], v[136:139], 0
    s_waitcnt lgkmcnt(7)
    v_mfma_f32_16x16x32_bf16 v[24:27], v[128:131], v[88:91], 0
    ds_read_b64_tr_b16 v[124:125], v8 offset:8192
    v_mfma_f32_16x16x32_bf16 v[40:43], v[128:131], v[92:95], 0
    ds_read_b64_tr_b16 v[126:127], v8 offset:9216
    v_mfma_f32_16x16x32_bf16 v[56:59], v[128:131], v[96:99], 0
    ds_read_b128 v[116:119], v6 offset:2048
    v_mfma_f32_16x16x32_bf16 v[72:75], v[128:131], v[100:103], 0
    v_add_u32 v7, s27, v7
    v_mfma_f32_16x16x32_bf16 v[140:143], v[136:139], v[88:91], 0
    v_add_u32 v5, s27, v5
    v_mfma_f32_16x16x32_bf16 v[148:151], v[88:91], v[88:91], 0
    s_waitcnt lgkmcnt(8)
    v_mfma_f32_16x16x32_bf16 v[28:31], v[132:135], v[88:91], 0
    ds_read_b64_tr_b16 v[128:129], v9 offset:8192
    v_mfma_f32_16x16x32_bf16 v[44:47], v[132:135], v[92:95], 0
    ds_read_b64_tr_b16 v[130:131], v9 offset:9216
    v_mfma_f32_16x16x32_bf16 v[60:63], v[132:135], v[96:99], 0
    v_add_u32 v8, s27, v8
    v_mfma_f32_16x16x32_bf16 v[76:79], v[132:135], v[100:103], 0
    v_add_u32 v6, s27, v6
    v_mfma_f32_16x16x32_bf16 v[144:147], v[136:139], v[92:95], 0
    v_add_u32 v9, s27, v9
    v_mfma_f32_16x16x32_bf16 v[152:155], v[92:95], v[92:95], 0
    s_branch L_p0qk_mid
L_p0qk_loop:
    s_waitcnt lgkmcnt(2)
    v_mfma_f32_16x16x32_bf16 v[16:19], v[120:123], v[88:91], v[16:19]
    ds_read_b64_tr_b16 v[132:133], v10 offset:0
    v_mfma_f32_16x16x32_bf16 v[32:35], v[120:123], v[92:95], v[32:35]
    ds_read_b64_tr_b16 v[134:135], v10 offset:1024
    v_mfma_f32_16x16x32_bf16 v[48:51], v[120:123], v[96:99], v[48:51]
    ds_read_b128 v[104:107], v5 offset:0
    v_mfma_f32_16x16x32_bf16 v[64:67], v[120:123], v[100:103], v[64:67]
    ds_read_b128 v[108:111], v5 offset:2048
    v_mfma_f32_16x16x32_bf16 v[80:83], v[120:123], v[136:139], v[80:83]
    v_add_u32 v3, s27, v3
    s_waitcnt lgkmcnt(4)
    v_mfma_f32_16x16x32_bf16 v[20:23], v[124:127], v[88:91], v[20:23]
    ds_read_b64_tr_b16 v[120:121], v7 offset:8192
    v_mfma_f32_16x16x32_bf16 v[36:39], v[124:127], v[92:95], v[36:39]
    ds_read_b64_tr_b16 v[122:123], v7 offset:9216
    v_mfma_f32_16x16x32_bf16 v[52:55], v[124:127], v[96:99], v[52:55]
    ds_read_b128 v[112:115], v6 offset:0
    v_mfma_f32_16x16x32_bf16 v[68:71], v[124:127], v[100:103], v[68:71]
    v_add_u32 v4, s27, v4
    v_mfma_f32_16x16x32_bf16 v[84:87], v[124:127], v[136:139], v[84:87]
    s_waitcnt lgkmcnt(7)
    v_mfma_f32_16x16x32_bf16 v[24:27], v[128:131], v[88:91], v[24:27]
    ds_read_b64_tr_b16 v[124:125], v8 offset:8192
    v_mfma_f32_16x16x32_bf16 v[40:43], v[128:131], v[92:95], v[40:43]
    ds_read_b64_tr_b16 v[126:127], v8 offset:9216
    v_mfma_f32_16x16x32_bf16 v[56:59], v[128:131], v[96:99], v[56:59]
    ds_read_b128 v[116:119], v6 offset:2048
    v_mfma_f32_16x16x32_bf16 v[72:75], v[128:131], v[100:103], v[72:75]
    v_add_u32 v7, s27, v7
    v_mfma_f32_16x16x32_bf16 v[140:143], v[136:139], v[88:91], v[140:143]
    v_add_u32 v5, s27, v5
    v_mfma_f32_16x16x32_bf16 v[148:151], v[88:91], v[88:91], v[148:151]
    s_waitcnt lgkmcnt(8)
    v_mfma_f32_16x16x32_bf16 v[28:31], v[132:135], v[88:91], v[28:31]
    ds_read_b64_tr_b16 v[128:129], v9 offset:8192
    v_mfma_f32_16x16x32_bf16 v[44:47], v[132:135], v[92:95], v[44:47]
    ds_read_b64_tr_b16 v[130:131], v9 offset:9216
    v_mfma_f32_16x16x32_bf16 v[60:63], v[132:135], v[96:99], v[60:63]
    v_add_u32 v8, s27, v8
    v_mfma_f32_16x16x32_bf16 v[76:79], v[132:135], v[100:103], v[76:79]
    v_add_u32 v6, s27, v6
    v_mfma_f32_16x16x32_bf16 v[144:147], v[136:139], v[92:95], v[144:147]
    v_add_u32 v9, s27, v9
    v_mfma_f32_16x16x32_bf16 v[152:155], v[92:95], v[92:95], v[152:155]
    s_cmp_eq_u32 s23, 9
    s_cbranch_scc1 L_p0qk_last
L_p0qk_mid:
    s_barrier
    s_waitcnt lgkmcnt(2)
    v_mfma_f32_16x16x32_bf16 v[16:19], v[120:123], v[104:107], v[16:19]
    ds_read_b64_tr_b16 v[132:133], v10 offset:8192
    v_mfma_f32_16x16x32_bf16 v[32:35], v[120:123], v[108:111], v[32:35]
    ds_read_b64_tr_b16 v[134:135], v10 offset:9216
    v_mfma_f32_16x16x32_bf16 v[48:51], v[120:123], v[112:115], v[48:51]
    ds_read_b128 v[88:91], v3 offset:0
    v_mfma_f32_16x16x32_bf16 v[64:67], v[120:123], v[116:119], v[64:67]
    ds_read_b128 v[92:95], v3 offset:2048
    v_mfma_f32_16x16x32_bf16 v[80:83], v[120:123], v[136:139], v[80:83]
    s_waitcnt lgkmcnt(4)
    v_mfma_f32_16x16x32_bf16 v[20:23], v[124:127], v[104:107], v[20:23]
    ds_read_b64_tr_b16 v[120:121], v7 offset:0
    v_mfma_f32_16x16x32_bf16 v[36:39], v[124:127], v[108:111], v[36:39]
    ds_read_b64_tr_b16 v[122:123], v7 offset:1024
    v_mfma_f32_16x16x32_bf16 v[52:55], v[124:127], v[112:115], v[52:55]
    ds_read_b128 v[96:99], v4 offset:0
    v_mfma_f32_16x16x32_bf16 v[68:71], v[124:127], v[116:119], v[68:71]
    v_add_u32 v10, s27, v10
    v_mfma_f32_16x16x32_bf16 v[84:87], v[124:127], v[136:139], v[84:87]
    s_waitcnt lgkmcnt(7)
    v_mfma_f32_16x16x32_bf16 v[24:27], v[128:131], v[104:107], v[24:27]
    ds_read_b64_tr_b16 v[124:125], v8 offset:0
    v_mfma_f32_16x16x32_bf16 v[40:43], v[128:131], v[108:111], v[40:43]
    ds_read_b64_tr_b16 v[126:127], v8 offset:1024
    v_mfma_f32_16x16x32_bf16 v[56:59], v[128:131], v[112:115], v[56:59]
    ds_read_b128 v[100:103], v4 offset:2048
    v_mfma_f32_16x16x32_bf16 v[72:75], v[128:131], v[116:119], v[72:75]
    s_add_u32 s23, s23, 1
    s_and_b32 s27, s23, 3
    v_mfma_f32_16x16x32_bf16 v[140:143], v[136:139], v[104:107], v[140:143]
    s_cmp_eq_u32 s27, 3
    s_mov_b32 s27, 32768
    s_cmov_b32 s27, 4294868992
    v_mfma_f32_16x16x32_bf16 v[148:151], v[104:107], v[104:107], v[148:151]
    s_waitcnt lgkmcnt(8)
    v_mfma_f32_16x16x32_bf16 v[28:31], v[132:135], v[104:107], v[28:31]
    ds_read_b64_tr_b16 v[128:129], v9 offset:0
    v_mfma_f32_16x16x32_bf16 v[44:47], v[132:135], v[108:111], v[44:47]
    ds_read_b64_tr_b16 v[130:131], v9 offset:1024
    v_mfma_f32_16x16x32_bf16 v[60:63], v[132:135], v[112:115], v[60:63]
    v_mfma_f32_16x16x32_bf16 v[76:79], v[132:135], v[116:119], v[76:79]
    v_mfma_f32_16x16x32_bf16 v[144:147], v[136:139], v[108:111], v[144:147]
    v_mfma_f32_16x16x32_bf16 v[152:155], v[108:111], v[108:111], v[152:155]
    s_branch L_p0qk_loop
L_p0qk_last:
    s_waitcnt lgkmcnt(0)
    v_mfma_f32_16x16x32_bf16 v[16:19], v[120:123], v[104:107], v[16:19]
    ds_read_b64_tr_b16 v[132:133], v10 offset:8192
    v_mfma_f32_16x16x32_bf16 v[32:35], v[120:123], v[108:111], v[32:35]
    ds_read_b64_tr_b16 v[134:135], v10 offset:9216
    v_mfma_f32_16x16x32_bf16 v[48:51], v[120:123], v[112:115], v[48:51]
    v_mfma_f32_16x16x32_bf16 v[64:67], v[120:123], v[116:119], v[64:67]
    v_mfma_f32_16x16x32_bf16 v[80:83], v[120:123], v[136:139], v[80:83]
    s_waitcnt lgkmcnt(2)
    v_mfma_f32_16x16x32_bf16 v[20:23], v[124:127], v[104:107], v[20:23]
    v_mfma_f32_16x16x32_bf16 v[36:39], v[124:127], v[108:111], v[36:39]
    v_mfma_f32_16x16x32_bf16 v[52:55], v[124:127], v[112:115], v[52:55]
    v_mfma_f32_16x16x32_bf16 v[68:71], v[124:127], v[116:119], v[68:71]
    v_mfma_f32_16x16x32_bf16 v[84:87], v[124:127], v[136:139], v[84:87]
    s_waitcnt lgkmcnt(2)
    v_mfma_f32_16x16x32_bf16 v[24:27], v[128:131], v[104:107], v[24:27]
    v_mfma_f32_16x16x32_bf16 v[40:43], v[128:131], v[108:111], v[40:43]
    v_mfma_f32_16x16x32_bf16 v[56:59], v[128:131], v[112:115], v[56:59]
    v_mfma_f32_16x16x32_bf16 v[72:75], v[128:131], v[116:119], v[72:75]
    v_mfma_f32_16x16x32_bf16 v[140:143], v[136:139], v[104:107], v[140:143]
    v_mfma_f32_16x16x32_bf16 v[148:151], v[104:107], v[104:107], v[148:151]
    s_waitcnt lgkmcnt(0)
    v_mfma_f32_16x16x32_bf16 v[28:31], v[132:135], v[104:107], v[28:31]
    v_mfma_f32_16x16x32_bf16 v[44:47], v[132:135], v[108:111], v[44:47]
    v_mfma_f32_16x16x32_bf16 v[60:63], v[132:135], v[112:115], v[60:63]
    v_mfma_f32_16x16x32_bf16 v[76:79], v[132:135], v[116:119], v[76:79]
    v_mfma_f32_16x16x32_bf16 v[144:147], v[136:139], v[108:111], v[144:147]
    v_mfma_f32_16x16x32_bf16 v[152:155], v[108:111], v[108:111], v[152:155]
    s_mov_b32 s28, 131072
    v_lshl_add_u32 v128, v1, 3, s28
    v_lshl_add_u32 v129, v2, 4, s28
    v_and_b32 v130, 3, v1
    v_cmp_eq_u32 s[50:51], 1, v130
    v_cmp_eq_u32 s[52:53], 2, v130
    v_cmp_eq_u32 s[54:55], 3, v130
    s_lshl_b32 s29, s42, 3
    v_add_u32 v130, s29, v128
    s_nop 1
    v_cndmask_b32 v148, v148, v149, s[50:51]
    v_cndmask_b32 v148, v148, v150, s[52:53]
    v_cndmask_b32 v148, v148, v151, s[54:55]
    v_mul_f32 v150, 0x3acccccd, v140
    v_mul_f32 v148, 0x3acccccd, v148
    v_fma_f32 v148, -v150, v150, v148
    v_max_f32 v148, 0, v148
    v_add_f32 v148, 0x3727c5ac, v148
    v_rsq_f32 v151, v148
    v_cndmask_b32 v152, v152, v153, s[50:51]
    v_cndmask_b32 v152, v152, v154, s[52:53]
    v_cndmask_b32 v152, v152, v155, s[54:55]
    v_mul_f32 v154, 0x3acccccd, v144
    v_mul_f32 v152, 0x3acccccd, v152
    v_fma_f32 v152, -v154, v154, v152
    v_max_f32 v152, 0, v152
    v_add_f32 v152, 0x3727c5ac, v152
    v_rsq_f32 v155, v152
    s_mov_b32 exec_lo, 0x00f0000f
    s_mov_b32 exec_hi, 0xf0000f00
    ds_write_b64 v130, v[150:151] offset:0
    ds_write_b64 v130, v[154:155] offset:128
    s_mov_b32 exec_lo, 0x00010001
    s_mov_b32 exec_hi, 0x00010001
    s_lshl_b32 s29, s38, 6
    v_add_u32 v131, s29, v129
    ds_write_b128 v131, v[80:83] offset:1024
    s_lshl_b32 s29, s39, 6
    v_add_u32 v131, s29, v129
    ds_write_b128 v131, v[84:87] offset:1024
    s_mov_b64 exec, -1
    s_waitcnt lgkmcnt(0)
    s_barrier
    s_lshl_b32 s29, s42, 3
    v_add_u32 v130, s29, v128
    ds_read_b64 v[120:121], v130 offset:0
    ds_read_b64 v[122:123], v130 offset:128
    s_lshl_b32 s29, s43, 3
    v_add_u32 v130, s29, v128
    ds_read_b64 v[124:125], v130 offset:0
    ds_read_b64 v[126:127], v130 offset:128
    s_lshl_b32 s29, s38, 6
    v_add_u32 v131, s29, v129
    ds_read_b128 v[88:91], v131 offset:1024
    s_lshl_b32 s29, s39, 6
    v_add_u32 v131, s29, v129
    ds_read_b128 v[92:95], v131 offset:1024
    s_lshl_b32 s29, s40, 6
    v_add_u32 v131, s29, v129
    ds_read_b128 v[96:99], v131 offset:1024
    s_lshl_b32 s29, s41, 6
    v_add_u32 v131, s29, v129
    ds_read_b128 v[100:103], v131 offset:1024
    s_waitcnt lgkmcnt(4)
    v_mul_f32 v80, s49, v121
    v_mul_f32 v82, s49, v123
    v_mul_f32 v84, s49, v125
    v_mul_f32 v86, s49, v127
    s_waitcnt lgkmcnt(0)
    v_pk_fma_f32 v[16:17], v[88:89], v[120:121], v[16:17] op_sel_hi:[1,0,1] neg_lo:[0,1,0] neg_hi:[0,1,0]
    v_pk_fma_f32 v[18:19], v[90:91], v[120:121], v[18:19] op_sel_hi:[1,0,1] neg_lo:[0,1,0] neg_hi:[0,1,0]
    v_pk_mul_f32 v[16:17], v[16:17], v[80:81] op_sel_hi:[1,0]
    v_pk_mul_f32 v[18:19], v[18:19], v[80:81] op_sel_hi:[1,0]
    v_pk_fma_f32 v[32:33], v[88:89], v[122:123], v[32:33] op_sel_hi:[1,0,1] neg_lo:[0,1,0] neg_hi:[0,1,0]
    v_pk_fma_f32 v[34:35], v[90:91], v[122:123], v[34:35] op_sel_hi:[1,0,1] neg_lo:[0,1,0] neg_hi:[0,1,0]
    v_pk_mul_f32 v[32:33], v[32:33], v[82:83] op_sel_hi:[1,0]
    v_pk_mul_f32 v[34:35], v[34:35], v[82:83] op_sel_hi:[1,0]
    v_cvt_pk_bf16_f32 v16, v16, v17
    v_cvt_pk_bf16_f32 v17, v18, v19
    v_cvt_pk_bf16_f32 v18, v32, v33
    v_cvt_pk_bf16_f32 v19, v34, v35
    buffer_store_dwordx4 v[16:19], v11, s[4:7], s30 offen sc1
    v_pk_fma_f32 v[48:49], v[88:89], v[124:125], v[48:49] op_sel_hi:[1,0,1] neg_lo:[0,1,0] neg_hi:[0,1,0]
    v_pk_fma_f32 v[50:51], v[90:91], v[124:125], v[50:51] op_sel_hi:[1,0,1] neg_lo:[0,1,0] neg_hi:[0,1,0]
    v_pk_mul_f32 v[48:49], v[48:49], v[84:85] op_sel_hi:[1,0]
    v_pk_mul_f32 v[50:51], v[50:51], v[84:85] op_sel_hi:[1,0]
    v_pk_fma_f32 v[64:65], v[88:89], v[126:127], v[64:65] op_sel_hi:[1,0,1] neg_lo:[0,1,0] neg_hi:[0,1,0]
    v_pk_fma_f32 v[66:67], v[90:91], v[126:127], v[66:67] op_sel_hi:[1,0,1] neg_lo:[0,1,0] neg_hi:[0,1,0]
    v_pk_mul_f32 v[64:65], v[64:65], v[86:87] op_sel_hi:[1,0]
    v_pk_mul_f32 v[66:67], v[66:67], v[86:87] op_sel_hi:[1,0]
    v_cvt_pk_bf16_f32 v48, v48, v49
    v_cvt_pk_bf16_f32 v49, v50, v51
    v_cvt_pk_bf16_f32 v50, v64, v65
    v_cvt_pk_bf16_f32 v51, v66, v67
    buffer_store_dwordx4 v[48:51], v11, s[4:7], s31 offen sc1
    v_pk_fma_f32 v[20:21], v[92:93], v[120:121], v[20:21] op_sel_hi:[1,0,1] neg_lo:[0,1,0] neg_hi:[0,1,0]
    v_pk_fma_f32 v[22:23], v[94:95], v[120:121], v[22:23] op_sel_hi:[1,0,1] neg_lo:[0,1,0] neg_hi:[0,1,0]
    v_pk_mul_f32 v[20:21], v[20:21], v[80:81] op_sel_hi:[1,0]
    v_pk_mul_f32 v[22:23], v[22:23], v[80:81] op_sel_hi:[1,0]
    v_pk_fma_f32 v[36:37], v[92:93], v[122:123], v[36:37] op_sel_hi:[1,0,1] neg_lo:[0,1,0] neg_hi:[0,1,0]
    v_pk_fma_f32 v[38:39], v[94:95], v[122:123], v[38:39] op_sel_hi:[1,0,1] neg_lo:[0,1,0] neg_hi:[0,1,0]
    v_pk_mul_f32 v[36:37], v[36:37], v[82:83] op_sel_hi:[1,0]
    v_pk_mul_f32 v[38:39], v[38:39], v[82:83] op_sel_hi:[1,0]
    v_cvt_pk_bf16_f32 v20, v20, v21
    v_cvt_pk_bf16_f32 v21, v22, v23
    v_cvt_pk_bf16_f32 v22, v36, v37
    v_cvt_pk_bf16_f32 v23, v38, v39
    buffer_store_dwordx4 v[20:23], v12, s[4:7], s30 offen sc1
    v_pk_fma_f32 v[52:53], v[92:93], v[124:125], v[52:53] op_sel_hi:[1,0,1] neg_lo:[0,1,0] neg_hi:[0,1,0]
    v_pk_fma_f32 v[54:55], v[94:95], v[124:125], v[54:55] op_sel_hi:[1,0,1] neg_lo:[0,1,0] neg_hi:[0,1,0]
    v_pk_mul_f32 v[52:53], v[52:53], v[84:85] op_sel_hi:[1,0]
    v_pk_mul_f32 v[54:55], v[54:55], v[84:85] op_sel_hi:[1,0]
    v_pk_fma_f32 v[68:69], v[92:93], v[126:127], v[68:69] op_sel_hi:[1,0,1] neg_lo:[0,1,0] neg_hi:[0,1,0]
    v_pk_fma_f32 v[70:71], v[94:95], v[126:127], v[70:71] op_sel_hi:[1,0,1] neg_lo:[0,1,0] neg_hi:[0,1,0]
    v_pk_mul_f32 v[68:69], v[68:69], v[86:87] op_sel_hi:[1,0]
    v_pk_mul_f32 v[70:71], v[70:71], v[86:87] op_sel_hi:[1,0]
    v_cvt_pk_bf16_f32 v52, v52, v53
    v_cvt_pk_bf16_f32 v53, v54, v55
    v_cvt_pk_bf16_f32 v54, v68, v69
    v_cvt_pk_bf16_f32 v55, v70, v71
    buffer_store_dwordx4 v[52:55], v12, s[4:7], s31 offen sc1
    v_pk_fma_f32 v[24:25], v[96:97], v[120:121], v[24:25] op_sel_hi:[1,0,1] neg_lo:[0,1,0] neg_hi:[0,1,0]
    v_pk_fma_f32 v[26:27], v[98:99], v[120:121], v[26:27] op_sel_hi:[1,0,1] neg_lo:[0,1,0] neg_hi:[0,1,0]
    v_pk_mul_f32 v[24:25], v[24:25], v[80:81] op_sel_hi:[1,0]
    v_pk_mul_f32 v[26:27], v[26:27], v[80:81] op_sel_hi:[1,0]
    v_pk_fma_f32 v[40:41], v[96:97], v[122:123], v[40:41] op_sel_hi:[1,0,1] neg_lo:[0,1,0] neg_hi:[0,1,0]
    v_pk_fma_f32 v[42:43], v[98:99], v[122:123], v[42:43] op_sel_hi:[1,0,1] neg_lo:[0,1,0] neg_hi:[0,1,0]
    v_pk_mul_f32 v[40:41], v[40:41], v[82:83] op_sel_hi:[1,0]
    v_pk_mul_f32 v[42:43], v[42:43], v[82:83] op_sel_hi:[1,0]
    v_cvt_pk_bf16_f32 v24, v24, v25
    v_cvt_pk_bf16_f32 v25, v26, v27
    v_cvt_pk_bf16_f32 v26, v40, v41
    v_cvt_pk_bf16_f32 v27, v42, v43
    buffer_store_dwordx4 v[24:27], v13, s[4:7], s30 offen sc1
    v_pk_fma_f32 v[56:57], v[96:97], v[124:125], v[56:57] op_sel_hi:[1,0,1] neg_lo:[0,1,0] neg_hi:[0,1,0]
    v_pk_fma_f32 v[58:59], v[98:99], v[124:125], v[58:59] op_sel_hi:[1,0,1] neg_lo:[0,1,0] neg_hi:[0,1,0]
    v_pk_mul_f32 v[56:57], v[56:57], v[84:85] op_sel_hi:[1,0]
    v_pk_mul_f32 v[58:59], v[58:59], v[84:85] op_sel_hi:[1,0]
    v_pk_fma_f32 v[72:73], v[96:97], v[126:127], v[72:73] op_sel_hi:[1,0,1] neg_lo:[0,1,0] neg_hi:[0,1,0]
    v_pk_fma_f32 v[74:75], v[98:99], v[126:127], v[74:75] op_sel_hi:[1,0,1] neg_lo:[0,1,0] neg_hi:[0,1,0]
    v_pk_mul_f32 v[72:73], v[72:73], v[86:87] op_sel_hi:[1,0]
    v_pk_mul_f32 v[74:75], v[74:75], v[86:87] op_sel_hi:[1,0]
    v_cvt_pk_bf16_f32 v56, v56, v57
    v_cvt_pk_bf16_f32 v57, v58, v59
    v_cvt_pk_bf16_f32 v58, v72, v73
    v_cvt_pk_bf16_f32 v59, v74, v75
    buffer_store_dwordx4 v[56:59], v13, s[4:7], s31 offen sc1
    v_pk_fma_f32 v[28:29], v[100:101], v[120:121], v[28:29] op_sel_hi:[1,0,1] neg_lo:[0,1,0] neg_hi:[0,1,0]
    v_pk_fma_f32 v[30:31], v[102:103], v[120:121], v[30:31] op_sel_hi:[1,0,1] neg_lo:[0,1,0] neg_hi:[0,1,0]
    v_pk_mul_f32 v[28:29], v[28:29], v[80:81] op_sel_hi:[1,0]
    v_pk_mul_f32 v[30:31], v[30:31], v[80:81] op_sel_hi:[1,0]
    v_pk_fma_f32 v[44:45], v[100:101], v[122:123], v[44:45] op_sel_hi:[1,0,1] neg_lo:[0,1,0] neg_hi:[0,1,0]
    v_pk_fma_f32 v[46:47], v[102:103], v[122:123], v[46:47] op_sel_hi:[1,0,1] neg_lo:[0,1,0] neg_hi:[0,1,0]
    v_pk_mul_f32 v[44:45], v[44:45], v[82:83] op_sel_hi:[1,0]
    v_pk_mul_f32 v[46:47], v[46:47], v[82:83] op_sel_hi:[1,0]
    v_cvt_pk_bf16_f32 v28, v28, v29
    v_cvt_pk_bf16_f32 v29, v30, v31
    v_cvt_pk_bf16_f32 v30, v44, v45
    v_cvt_pk_bf16_f32 v31, v46, v47
    buffer_store_dwordx4 v[28:31], v14, s[4:7], s30 offen sc1
    v_pk_fma_f32 v[60:61], v[100:101], v[124:125], v[60:61] op_sel_hi:[1,0,1] neg_lo:[0,1,0] neg_hi:[0,1,0]
    v_pk_fma_f32 v[62:63], v[102:103], v[124:125], v[62:63] op_sel_hi:[1,0,1] neg_lo:[0,1,0] neg_hi:[0,1,0]
    v_pk_mul_f32 v[60:61], v[60:61], v[84:85] op_sel_hi:[1,0]
    v_pk_mul_f32 v[62:63], v[62:63], v[84:85] op_sel_hi:[1,0]
    v_pk_fma_f32 v[76:77], v[100:101], v[126:127], v[76:77] op_sel_hi:[1,0,1] neg_lo:[0,1,0] neg_hi:[0,1,0]
    v_pk_fma_f32 v[78:79], v[102:103], v[126:127], v[78:79] op_sel_hi:[1,0,1] neg_lo:[0,1,0] neg_hi:[0,1,0]
    v_pk_mul_f32 v[76:77], v[76:77], v[86:87] op_sel_hi:[1,0]
    v_pk_mul_f32 v[78:79], v[78:79], v[86:87] op_sel_hi:[1,0]
    v_cvt_pk_bf16_f32 v60, v60, v61
    v_cvt_pk_bf16_f32 v61, v62, v63
    v_cvt_pk_bf16_f32 v62, v76, v77
    v_cvt_pk_bf16_f32 v63, v78, v79
    buffer_store_dwordx4 v[60:63], v14, s[4:7], s31 offen sc1
    s_branch L_p0_sig
L_p0_v:
    v_and_b32 v1, 15, v0
    v_lshrrev_b32 v2, 4, v0
    v_lshrrev_b32 v16, 1, v1
    v_xor_b32 v16, v16, v2
    v_lshlrev_b32 v16, 4, v16
    v_lshl_add_u32 v16, v1, 7, v16
    s_lshr_b32 s36, s3, 1
    s_and_b32 s37, s3, 1
    s_lshl_b32 s28, s37, 2
    s_lshl_b32 s29, s36, 1
    s_add_u32 s38, s28, s29
    s_add_u32 s39, s38, 1
    s_xor_b32 s40, s38, 2
    s_xor_b32 s41, s39, 2
    s_lshl_b32 s42, s36, 6
    s_lshl_b32 s28, s37, 5
    s_add_u32 s42, s42, s28
    s_xor_b32 s43, s42, 32
    s_lshl_b32 s28, s42, 7
    s_lshl_b32 s29, s43, 7
    v_add_u32 v3, s28, v16
    v_add_u32 v4, s29, v16
    v_xor_b32 v5, 64, v3
    v_xor_b32 v6, 64, v4
    v_lshrrev_b32 v17, 2, v1
    v_lshl_add_u32 v18, v2, 3, v17
    v_lshlrev_b32 v18, 8, v18
    v_and_b32 v19, 1, v2
    v_lshl_or_b32 v17, v19, 2, v17
    v_and_b32 v19, 3, v1
    v_lshl_add_u32 v18, v19, 3, v18
    v_add_u32 v18, 16384, v18
    v_xor_b32 v19, s38, v17
    v_lshl_add_u32 v7, v19, 5, v18
    v_mov_b32 v136, 1065369472
    v_xor_b32 v19, s39, v17
    v_lshl_add_u32 v8, v19, 5, v18
    v_mov_b32 v137, 1065369472
    v_xor_b32 v19, s40, v17
    v_lshl_add_u32 v9, v19, 5, v18
    v_mov_b32 v138, 1065369472
    v_xor_b32 v19, s41, v17
    v_lshl_add_u32 v10, v19, 5, v18
    v_mov_b32 v139, 1065369472
    s_cmp_ge_u32 s21, 5
    s_cselect_b32 s46, 1, 0
    s_mul_i32 s28, s46, 10
    s_sub_u32 s44, s21, s28
    s_lshl_b32 s45, s44, 1
    s_add_u32 s45, s45, s37
    s_lshl_b32 s29, s20, 2
    s_lshl_b32 s47, 1280, s46
    s_lshr_b32 s28, s42, 5
    s_add_u32 s28, s28, s29
    s_mul_i32 s30, s28, s47
    s_add_u32 s30, s30, 7741440
    s_lshr_b32 s28, s43, 5
    s_add_u32 s28, s28, s29
    s_mul_i32 s31, s28, s47
    s_add_u32 s31, s31, 7741440
    s_lshl_b32 s44, s44, 7
    s_mov_b32 s47, 163520
    v_mul_u32_u24 v18, 320, v2
    v_add_u32 v18, 2622720, v18
    s_lshl_b32 s28, s38, 4
    s_add_u32 s28, s28, s44
    v_add_u32 v17, s28, v1
    v_mul_u32_u24 v16, 3277, v17
    v_lshrrev_b32 v16, 16, v16
    v_lshl_add_u32 v17, v17, 4, v18
    v_mad_u32_u24 v11, v16, s47, v17
    s_lshl_b32 s28, s39, 4
    s_add_u32 s28, s28, s44
    v_add_u32 v17, s28, v1
    v_mul_u32_u24 v16, 3277, v17
    v_lshrrev_b32 v16, 16, v16
    v_lshl_add_u32 v17, v17, 4, v18
    v_mad_u32_u24 v12, v16, s47, v17
    s_lshl_b32 s28, s40, 4
    s_add_u32 s28, s28, s44
    v_add_u32 v17, s28, v1
    v_mul_u32_u24 v16, 3277, v17
    v_lshrrev_b32 v16, 16, v16
    v_lshl_add_u32 v17, v17, 4, v18
    v_mad_u32_u24 v13, v16, s47, v17
    s_lshl_b32 s28, s41, 4
    s_add_u32 s28, s28, s44
    v_add_u32 v17, s28, v1
    v_mul_u32_u24 v16, 3277, v17
    v_lshrrev_b32 v16, 16, v16
    v_lshl_add_u32 v17, v17, 4, v18
    v_mad_u32_u24 v14, v16, s47, v17
    s_mov_b32 s23, 0
    s_mov_b32 s27, 32768
    s_waitcnt lgkmcnt(0)
    s_barrier
    ds_read_b128 v[88:91], v3 offset:0
    ds_read_b128 v[92:95], v3 offset:2048
    ds_read_b128 v[96:99], v4 offset:0
    ds_read_b128 v[100:103], v4 offset:2048
    ds_read_b64_tr_b16 v[120:121], v7 offset:0
    ds_read_b64_tr_b16 v[122:123], v7 offset:1024
    ds_read_b64_tr_b16 v[124:125], v8 offset:0
    ds_read_b64_tr_b16 v[126:127], v8 offset:1024
    ds_read_b64_tr_b16 v[128:129], v9 offset:0
    ds_read_b64_tr_b16 v[130:131], v9 offset:1024
    ds_read_b64_tr_b16 v[132:133], v10 offset:0
    ds_read_b64_tr_b16 v[134:135], v10 offset:1024
    s_waitcnt lgkmcnt(6)
    v_mfma_f32_16x16x32_bf16 v[16:19], v[88:91], v[120:123], 0
    ds_read_b128 v[104:107], v5 offset:0
    v_mfma_f32_16x16x32_bf16 v[32:35], v[92:95], v[120:123], 0
    ds_read_b128 v[108:111], v5 offset:2048
    v_mfma_f32_16x16x32_bf16 v[48:51], v[96:99], v[120:123], 0
    v_add_u32 v3, s27, v3
    v_mfma_f32_16x16x32_bf16 v[64:67], v[100:103], v[120:123], 0
    v_mfma_f32_16x16x32_bf16 v[80:83], v[120:123], v[136:139], 0
    s_waitcnt lgkmcnt(6)
    v_mfma_f32_16x16x32_bf16 v[20:23], v[88:91], v[124:127], 0
    ds_read_b64_tr_b16 v[120:121], v7 offset:8192
    v_mfma_f32_16x16x32_bf16 v[36:39], v[92:95], v[124:127], 0
    ds_read_b64_tr_b16 v[122:123], v7 offset:9216
    v_mfma_f32_16x16x32_bf16 v[52:55], v[96:99], v[124:127], 0
    ds_read_b128 v[112:115], v6 offset:0
    v_mfma_f32_16x16x32_bf16 v[68:71], v[100:103], v[124:127], 0
    v_add_u32 v4, s27, v4
    v_mfma_f32_16x16x32_bf16 v[84:87], v[124:127], v[136:139], 0
    s_waitcnt lgkmcnt(7)
    v_mfma_f32_16x16x32_bf16 v[24:27], v[88:91], v[128:131], 0
    ds_read_b64_tr_b16 v[124:125], v8 offset:8192
    v_mfma_f32_16x16x32_bf16 v[40:43], v[92:95], v[128:131], 0
    ds_read_b64_tr_b16 v[126:127], v8 offset:9216
    v_mfma_f32_16x16x32_bf16 v[56:59], v[96:99], v[128:131], 0
    ds_read_b128 v[116:119], v6 offset:2048
    v_mfma_f32_16x16x32_bf16 v[72:75], v[100:103], v[128:131], 0
    v_add_u32 v7, s27, v7
    v_mfma_f32_16x16x32_bf16 v[140:143], v[136:139], v[88:91], 0
    v_add_u32 v5, s27, v5
    v_mfma_f32_16x16x32_bf16 v[148:151], v[88:91], v[88:91], 0
    s_waitcnt lgkmcnt(8)
    v_mfma_f32_16x16x32_bf16 v[28:31], v[88:91], v[132:135], 0
    ds_read_b64_tr_b16 v[128:129], v9 offset:8192
    v_mfma_f32_16x16x32_bf16 v[44:47], v[92:95], v[132:135], 0
    ds_read_b64_tr_b16 v[130:131], v9 offset:9216
    v_mfma_f32_16x16x32_bf16 v[60:63], v[96:99], v[132:135], 0
    v_add_u32 v8, s27, v8
    v_mfma_f32_16x16x32_bf16 v[76:79], v[100:103], v[132:135], 0
    v_add_u32 v6, s27, v6
    v_mfma_f32_16x16x32_bf16 v[144:147], v[136:139], v[92:95], 0
    v_add_u32 v9, s27, v9
    v_mfma_f32_16x16x32_bf16 v[152:155], v[92:95], v[92:95], 0
    s_branch L_p0v_mid
L_p0v_loop:
    s_waitcnt lgkmcnt(2)
    v_mfma_f32_16x16x32_bf16 v[16:19], v[88:91], v[120:123], v[16:19]
    ds_read_b64_tr_b16 v[132:133], v10 offset:0
    v_mfma_f32_16x16x32_bf16 v[32:35], v[92:95], v[120:123], v[32:35]
    ds_read_b64_tr_b16 v[134:135], v10 offset:1024
    v_mfma_f32_16x16x32_bf16 v[48:51], v[96:99], v[120:123], v[48:51]
    ds_read_b128 v[104:107], v5 offset:0
    v_mfma_f32_16x16x32_bf16 v[64:67], v[100:103], v[120:123], v[64:67]
    ds_read_b128 v[108:111], v5 offset:2048
    v_mfma_f32_16x16x32_bf16 v[80:83], v[120:123], v[136:139], v[80:83]
    v_add_u32 v3, s27, v3
    s_waitcnt lgkmcnt(4)
    v_mfma_f32_16x16x32_bf16 v[20:23], v[88:91], v[124:127], v[20:23]
    ds_read_b64_tr_b16 v[120:121], v7 offset:8192
    v_mfma_f32_16x16x32_bf16 v[36:39], v[92:95], v[124:127], v[36:39]
    ds_read_b64_tr_b16 v[122:123], v7 offset:9216
    v_mfma_f32_16x16x32_bf16 v[52:55], v[96:99], v[124:127], v[52:55]
    ds_read_b128 v[112:115], v6 offset:0
    v_mfma_f32_16x16x32_bf16 v[68:71], v[100:103], v[124:127], v[68:71]
    v_add_u32 v4, s27, v4
    v_mfma_f32_16x16x32_bf16 v[84:87], v[124:127], v[136:139], v[84:87]
    s_waitcnt lgkmcnt(7)
    v_mfma_f32_16x16x32_bf16 v[24:27], v[88:91], v[128:131], v[24:27]
    ds_read_b64_tr_b16 v[124:125], v8 offset:8192
    v_mfma_f32_16x16x32_bf16 v[40:43], v[92:95], v[128:131], v[40:43]
    ds_read_b64_tr_b16 v[126:127], v8 offset:9216
    v_mfma_f32_16x16x32_bf16 v[56:59], v[96:99], v[128:131], v[56:59]
    ds_read_b128 v[116:119], v6 offset:2048
    v_mfma_f32_16x16x32_bf16 v[72:75], v[100:103], v[128:131], v[72:75]
    v_add_u32 v7, s27, v7
    v_mfma_f32_16x16x32_bf16 v[140:143], v[136:139], v[88:91], v[140:143]
    v_add_u32 v5, s27, v5
    v_mfma_f32_16x16x32_bf16 v[148:151], v[88:91], v[88:91], v[148:151]
    s_waitcnt lgkmcnt(8)
    v_mfma_f32_16x16x32_bf16 v[28:31], v[88:91], v[132:135], v[28:31]
    ds_read_b64_tr_b16 v[128:129], v9 offset:8192
    v_mfma_f32_16x16x32_bf16 v[44:47], v[92:95], v[132:135], v[44:47]
    ds_read_b64_tr_b16 v[130:131], v9 offset:9216
    v_mfma_f32_16x16x32_bf16 v[60:63], v[96:99], v[132:135], v[60:63]
    v_add_u32 v8, s27, v8
    v_mfma_f32_16x16x32_bf16 v[76:79], v[100:103], v[132:135], v[76:79]
    v_add_u32 v6, s27, v6
    v_mfma_f32_16x16x32_bf16 v[144:147], v[136:139], v[92:95], v[144:147]
    v_add_u32 v9, s27, v9
    v_mfma_f32_16x16x32_bf16 v[152:155], v[92:95], v[92:95], v[152:155]
    s_cmp_eq_u32 s23, 9
    s_cbranch_scc1 L_p0v_last
L_p0v_mid:
    s_barrier
    s_waitcnt lgkmcnt(2)
    v_mfma_f32_16x16x32_bf16 v[16:19], v[104:107], v[120:123], v[16:19]
    ds_read_b64_tr_b16 v[132:133], v10 offset:8192
    v_mfma_f32_16x16x32_bf16 v[32:35], v[108:111], v[120:123], v[32:35]
    ds_read_b64_tr_b16 v[134:135], v10 offset:9216
    v_mfma_f32_16x16x32_bf16 v[48:51], v[112:115], v[120:123], v[48:51]
    ds_read_b128 v[88:91], v3 offset:0
    v_mfma_f32_16x16x32_bf16 v[64:67], v[116:119], v[120:123], v[64:67]
    ds_read_b128 v[92:95], v3 offset:2048
    v_mfma_f32_16x16x32_bf16 v[80:83], v[120:123], v[136:139], v[80:83]
    s_waitcnt lgkmcnt(4)
    v_mfma_f32_16x16x32_bf16 v[20:23], v[104:107], v[124:127], v[20:23]
    ds_read_b64_tr_b16 v[120:121], v7 offset:0
    v_mfma_f32_16x16x32_bf16 v[36:39], v[108:111], v[124:127], v[36:39]
    ds_read_b64_tr_b16 v[122:123], v7 offset:1024
    v_mfma_f32_16x16x32_bf16 v[52:55], v[112:115], v[124:127], v[52:55]
    ds_read_b128 v[96:99], v4 offset:0
    v_mfma_f32_16x16x32_bf16 v[68:71], v[116:119], v[124:127], v[68:71]
    v_add_u32 v10, s27, v10
    v_mfma_f32_16x16x32_bf16 v[84:87], v[124:127], v[136:139], v[84:87]
    s_waitcnt lgkmcnt(7)
    v_mfma_f32_16x16x32_bf16 v[24:27], v[104:107], v[128:131], v[24:27]
    ds_read_b64_tr_b16 v[124:125], v8 offset:0
    v_mfma_f32_16x16x32_bf16 v[40:43], v[108:111], v[128:131], v[40:43]
    ds_read_b64_tr_b16 v[126:127], v8 offset:1024
    v_mfma_f32_16x16x32_bf16 v[56:59], v[112:115], v[128:131], v[56:59]
    ds_read_b128 v[100:103], v4 offset:2048
    v_mfma_f32_16x16x32_bf16 v[72:75], v[116:119], v[128:131], v[72:75]
    s_add_u32 s23, s23, 1
    s_and_b32 s27, s23, 3
    v_mfma_f32_16x16x32_bf16 v[140:143], v[136:139], v[104:107], v[140:143]
    s_cmp_eq_u32 s27, 3
    s_mov_b32 s27, 32768
    s_cmov_b32 s27, 4294868992
    v_mfma_f32_16x16x32_bf16 v[148:151], v[104:107], v[104:107], v[148:151]
    s_waitcnt lgkmcnt(8)
    v_mfma_f32_16x16x32_bf16 v[28:31], v[104:107], v[132:135], v[28:31]
    ds_read_b64_tr_b16 v[128:129], v9 offset:0
    v_mfma_f32_16x16x32_bf16 v[44:47], v[108:111], v[132:135], v[44:47]
    ds_read_b64_tr_b16 v[130:131], v9 offset:1024
    v_mfma_f32_16x16x32_bf16 v[60:63], v[112:115], v[132:135], v[60:63]
    v_mfma_f32_16x16x32_bf16 v[76:79], v[116:119], v[132:135], v[76:79]
    v_mfma_f32_16x16x32_bf16 v[144:147], v[136:139], v[108:111], v[144:147]
    v_mfma_f32_16x16x32_bf16 v[152:155], v[108:111], v[108:111], v[152:155]
    s_branch L_p0v_loop
L_p0v_last:
    s_waitcnt lgkmcnt(0)
    v_mfma_f32_16x16x32_bf16 v[16:19], v[104:107], v[120:123], v[16:19]
    ds_read_b64_tr_b16 v[132:133], v10 offset:8192
    v_mfma_f32_16x16x32_bf16 v[32:35], v[108:111], v[120:123], v[32:35]
    ds_read_b64_tr_b16 v[134:135], v10 offset:9216
    v_mfma_f32_16x16x32_bf16 v[48:51], v[112:115], v[120:123], v[48:51]
    v_mfma_f32_16x16x32_bf16 v[64:67], v[116:119], v[120:123], v[64:67]
    v_mfma_f32_16x16x32_bf16 v[80:83], v[120:123], v[136:139], v[80:83]
    s_waitcnt lgkmcnt(2)
    v_mfma_f32_16x16x32_bf16 v[20:23], v[104:107], v[124:127], v[20:23]
    v_mfma_f32_16x16x32_bf16 v[36:39], v[108:111], v[124:127], v[36:39]
    v_mfma_f32_16x16x32_bf16 v[52:55], v[112:115], v[124:127], v[52:55]
    v_mfma_f32_16x16x32_bf16 v[68:71], v[116:119], v[124:127], v[68:71]
    v_mfma_f32_16x16x32_bf16 v[84:87], v[124:127], v[136:139], v[84:87]
    s_waitcnt lgkmcnt(2)
    v_mfma_f32_16x16x32_bf16 v[24:27], v[104:107], v[128:131], v[24:27]
    v_mfma_f32_16x16x32_bf16 v[40:43], v[108:111], v[128:131], v[40:43]
    v_mfma_f32_16x16x32_bf16 v[56:59], v[112:115], v[128:131], v[56:59]
    v_mfma_f32_16x16x32_bf16 v[72:75], v[116:119], v[128:131], v[72:75]
    v_mfma_f32_16x16x32_bf16 v[140:143], v[136:139], v[104:107], v[140:143]
    v_mfma_f32_16x16x32_bf16 v[148:151], v[104:107], v[104:107], v[148:151]
    s_waitcnt lgkmcnt(0)
    v_mfma_f32_16x16x32_bf16 v[28:31], v[104:107], v[132:135], v[28:31]
    v_mfma_f32_16x16x32_bf16 v[44:47], v[108:111], v[132:135], v[44:47]
    v_mfma_f32_16x16x32_bf16 v[60:63], v[112:115], v[132:135], v[60:63]
    v_mfma_f32_16x16x32_bf16 v[76:79], v[116:119], v[132:135], v[76:79]
    v_mfma_f32_16x16x32_bf16 v[144:147], v[136:139], v[108:111], v[144:147]
    v_mfma_f32_16x16x32_bf16 v[152:155], v[108:111], v[108:111], v[152:155]
    s_mov_b32 s28, 131072
    v_lshl_add_u32 v128, v1, 3, s28
    v_lshl_add_u32 v129, v2, 4, s28
    v_and_b32 v130, 3, v1
    v_cmp_eq_u32 s[50:51], 1, v130
    v_cmp_eq_u32 s[52:53], 2, v130
    v_cmp_eq_u32 s[54:55], 3, v130
    s_lshl_b32 s29, s42, 3
    v_add_u32 v130, s29, v128
    s_nop 1
    v_cndmask_b32 v148, v148, v149, s[50:51]
    v_cndmask_b32 v148, v148, v150, s[52:53]
    v_cndmask_b32 v148, v148, v151, s[54:55]
    v_mul_f32 v150, 0x3acccccd, v140
    v_mul_f32 v148, 0x3acccccd, v148
    v_fma_f32 v148, -v150, v150, v148
    v_max_f32 v148, 0, v148
    v_add_f32 v148, 0x3727c5ac, v148
    v_rsq_f32 v151, v148
    v_cndmask_b32 v152, v152, v153, s[50:51]
    v_cndmask_b32 v152, v152, v154, s[52:53]
    v_cndmask_b32 v152, v152, v155, s[54:55]
    v_mul_f32 v154, 0x3acccccd, v144
    v_mul_f32 v152, 0x3acccccd, v152
    v_fma_f32 v152, -v154, v154, v152
    v_max_f32 v152, 0, v152
    v_add_f32 v152, 0x3727c5ac, v152
    v_rsq_f32 v155, v152
    s_mov_b32 exec_lo, 0x00f0000f
    s_mov_b32 exec_hi, 0xf0000f00
    ds_write_b64 v130, v[150:151] offset:0
    ds_write_b64 v130, v[154:155] offset:128
    s_mov_b32 exec_lo, 0x00010001
    s_mov_b32 exec_hi, 0x00010001
    s_lshl_b32 s29, s38, 6
    v_add_u32 v131, s29, v129
    ds_write_b128 v131, v[80:83] offset:1024
    s_lshl_b32 s29, s39, 6
    v_add_u32 v131, s29, v129
    ds_write_b128 v131, v[84:87] offset:1024
    s_mov_b64 exec, -1
    s_waitcnt lgkmcnt(0)
    s_barrier
    v_lshl_add_u32 v132, v2, 5, s28
    v_lshl_add_u32 v133, v1, 2, s28
    s_lshl_b32 s29, s42, 3
    v_add_u32 v130, s29, v132
    ds_read2_b32 v[88:89], v130 offset0:0 offset1:2
    ds_read2_b32 v[104:105], v130 offset0:1 offset1:3
    ds_read2_b32 v[90:91], v130 offset0:4 offset1:6
    ds_read2_b32 v[106:107], v130 offset0:5 offset1:7
    ds_read2_b32 v[92:93], v130 offset0:32 offset1:34
    ds_read2_b32 v[108:109], v130 offset0:33 offset1:35
    ds_read2_b32 v[94:95], v130 offset0:36 offset1:38
    ds_read2_b32 v[110:111], v130 offset0:37 offset1:39
    s_lshl_b32 s29, s38, 6
    v_add_u32 v131, s29, v133
    ds_read_b32 v120, v131 offset:1024
    s_lshl_b32 s29, s39, 6
    v_add_u32 v131, s29, v133
    ds_read_b32 v122, v131 offset:1024
    s_lshl_b32 s29, s40, 6
    v_add_u32 v131, s29, v133
    ds_read_b32 v136, v131 offset:1024
    s_lshl_b32 s29, s41, 6
    v_add_u32 v131, s29, v133
    ds_read_b32 v138, v131 offset:1024
    s_waitcnt lgkmcnt(0)
    s_lshl_b32 s29, s43, 3
    v_add_u32 v130, s29, v132
    ds_read2_b32 v[96:97], v130 offset0:0 offset1:2
    ds_read2_b32 v[112:113], v130 offset0:1 offset1:3
    ds_read2_b32 v[98:99], v130 offset0:4 offset1:6
    ds_read2_b32 v[114:115], v130 offset0:5 offset1:7
    ds_read2_b32 v[100:101], v130 offset0:32 offset1:34
    ds_read2_b32 v[116:117], v130 offset0:33 offset1:35
    ds_read2_b32 v[102:103], v130 offset0:36 offset1:38
    ds_read2_b32 v[118:119], v130 offset0:37 offset1:39
    v_pk_fma_f32 v[16:17], v[88:89], v[120:121], v[16:17] op_sel_hi:[1,0,1] neg_lo:[1,0,0] neg_hi:[1,0,0]
    v_pk_fma_f32 v[18:19], v[90:91], v[120:121], v[18:19] op_sel_hi:[1,0,1] neg_lo:[1,0,0] neg_hi:[1,0,0]
    v_pk_mul_f32 v[16:17], v[16:17], v[104:105]
    v_pk_mul_f32 v[18:19], v[18:19], v[106:107]
    v_pk_fma_f32 v[32:33], v[92:93], v[120:121], v[32:33] op_sel_hi:[1,0,1] neg_lo:[1,0,0] neg_hi:[1,0,0]
    v_pk_fma_f32 v[34:35], v[94:95], v[120:121], v[34:35] op_sel_hi:[1,0,1] neg_lo:[1,0,0] neg_hi:[1,0,0]
    v_pk_mul_f32 v[32:33], v[32:33], v[108:109]
    v_pk_mul_f32 v[34:35], v[34:35], v[110:111]
    v_cvt_pk_bf16_f32 v16, v16, v32
    v_cvt_pk_bf16_f32 v17, v17, v33
    v_cvt_pk_bf16_f32 v18, v18, v34
    v_cvt_pk_bf16_f32 v19, v19, v35
    s_nop 1
    v_permlane16_swap_b32 v16, v18
    v_permlane16_swap_b32 v17, v19
    buffer_store_dwordx4 v[16:19], v11, s[4:7], s30 offen sc1
    v_pk_fma_f32 v[20:21], v[88:89], v[122:123], v[20:21] op_sel_hi:[1,0,1] neg_lo:[1,0,0] neg_hi:[1,0,0]
    v_pk_fma_f32 v[22:23], v[90:91], v[122:123], v[22:23] op_sel_hi:[1,0,1] neg_lo:[1,0,0] neg_hi:[1,0,0]
    v_pk_mul_f32 v[20:21], v[20:21], v[104:105]
    v_pk_mul_f32 v[22:23], v[22:23], v[106:107]
    v_pk_fma_f32 v[36:37], v[92:93], v[122:123], v[36:37] op_sel_hi:[1,0,1] neg_lo:[1,0,0] neg_hi:[1,0,0]
    v_pk_fma_f32 v[38:39], v[94:95], v[122:123], v[38:39] op_sel_hi:[1,0,1] neg_lo:[1,0,0] neg_hi:[1,0,0]
    v_pk_mul_f32 v[36:37], v[36:37], v[108:109]
    v_pk_mul_f32 v[38:39], v[38:39], v[110:111]
    v_cvt_pk_bf16_f32 v20, v20, v36
    v_cvt_pk_bf16_f32 v21, v21, v37
    v_cvt_pk_bf16_f32 v22, v22, v38
    v_cvt_pk_bf16_f32 v23, v23, v39
    s_nop 1
    v_permlane16_swap_b32 v20, v22
    v_permlane16_swap_b32 v21, v23
    buffer_store_dwordx4 v[20:23], v12, s[4:7], s30 offen sc1
    v_pk_fma_f32 v[24:25], v[88:89], v[136:137], v[24:25] op_sel_hi:[1,0,1] neg_lo:[1,0,0] neg_hi:[1,0,0]
    v_pk_fma_f32 v[26:27], v[90:91], v[136:137], v[26:27] op_sel_hi:[1,0,1] neg_lo:[1,0,0] neg_hi:[1,0,0]
    v_pk_mul_f32 v[24:25], v[24:25], v[104:105]
    v_pk_mul_f32 v[26:27], v[26:27], v[106:107]
    v_pk_fma_f32 v[40:41], v[92:93], v[136:137], v[40:41] op_sel_hi:[1,0,1] neg_lo:[1,0,0] neg_hi:[1,0,0]
    v_pk_fma_f32 v[42:43], v[94:95], v[136:137], v[42:43] op_sel_hi:[1,0,1] neg_lo:[1,0,0] neg_hi:[1,0,0]
    v_pk_mul_f32 v[40:41], v[40:41], v[108:109]
    v_pk_mul_f32 v[42:43], v[42:43], v[110:111]
    v_cvt_pk_bf16_f32 v24, v24, v40
    v_cvt_pk_bf16_f32 v25, v25, v41
    v_cvt_pk_bf16_f32 v26, v26, v42
    v_cvt_pk_bf16_f32 v27, v27, v43
    s_nop 1
    v_permlane16_swap_b32 v24, v26
    v_permlane16_swap_b32 v25, v27
    buffer_store_dwordx4 v[24:27], v13, s[4:7], s30 offen sc1
    v_pk_fma_f32 v[28:29], v[88:89], v[138:139], v[28:29] op_sel_hi:[1,0,1] neg_lo:[1,0,0] neg_hi:[1,0,0]
    v_pk_fma_f32 v[30:31], v[90:91], v[138:139], v[30:31] op_sel_hi:[1,0,1] neg_lo:[1,0,0] neg_hi:[1,0,0]
    v_pk_mul_f32 v[28:29], v[28:29], v[104:105]
    v_pk_mul_f32 v[30:31], v[30:31], v[106:107]
    v_pk_fma_f32 v[44:45], v[92:93], v[138:139], v[44:45] op_sel_hi:[1,0,1] neg_lo:[1,0,0] neg_hi:[1,0,0]
    v_pk_fma_f32 v[46:47], v[94:95], v[138:139], v[46:47] op_sel_hi:[1,0,1] neg_lo:[1,0,0] neg_hi:[1,0,0]
    v_pk_mul_f32 v[44:45], v[44:45], v[108:109]
    v_pk_mul_f32 v[46:47], v[46:47], v[110:111]
    v_cvt_pk_bf16_f32 v28, v28, v44
    v_cvt_pk_bf16_f32 v29, v29, v45
    v_cvt_pk_bf16_f32 v30, v30, v46
    v_cvt_pk_bf16_f32 v31, v31, v47
    s_nop 1
    v_permlane16_swap_b32 v28, v30
    v_permlane16_swap_b32 v29, v31
    buffer_store_dwordx4 v[28:31], v14, s[4:7], s30 offen sc1
    s_waitcnt lgkmcnt(0)
    v_pk_fma_f32 v[48:49], v[96:97], v[120:121], v[48:49] op_sel_hi:[1,0,1] neg_lo:[1,0,0] neg_hi:[1,0,0]
    v_pk_fma_f32 v[50:51], v[98:99], v[120:121], v[50:51] op_sel_hi:[1,0,1] neg_lo:[1,0,0] neg_hi:[1,0,0]
    v_pk_mul_f32 v[48:49], v[48:49], v[112:113]
    v_pk_mul_f32 v[50:51], v[50:51], v[114:115]
    v_pk_fma_f32 v[64:65], v[100:101], v[120:121], v[64:65] op_sel_hi:[1,0,1] neg_lo:[1,0,0] neg_hi:[1,0,0]
    v_pk_fma_f32 v[66:67], v[102:103], v[120:121], v[66:67] op_sel_hi:[1,0,1] neg_lo:[1,0,0] neg_hi:[1,0,0]
    v_pk_mul_f32 v[64:65], v[64:65], v[116:117]
    v_pk_mul_f32 v[66:67], v[66:67], v[118:119]
    v_cvt_pk_bf16_f32 v48, v48, v64
    v_cvt_pk_bf16_f32 v49, v49, v65
    v_cvt_pk_bf16_f32 v50, v50, v66
    v_cvt_pk_bf16_f32 v51, v51, v67
    s_nop 1
    v_permlane16_swap_b32 v48, v50
    v_permlane16_swap_b32 v49, v51
    buffer_store_dwordx4 v[48:51], v11, s[4:7], s31 offen sc1
    v_pk_fma_f32 v[52:53], v[96:97], v[122:123], v[52:53] op_sel_hi:[1,0,1] neg_lo:[1,0,0] neg_hi:[1,0,0]
    v_pk_fma_f32 v[54:55], v[98:99], v[122:123], v[54:55] op_sel_hi:[1,0,1] neg_lo:[1,0,0] neg_hi:[1,0,0]
    v_pk_mul_f32 v[52:53], v[52:53], v[112:113]
    v_pk_mul_f32 v[54:55], v[54:55], v[114:115]
    v_pk_fma_f32 v[68:69], v[100:101], v[122:123], v[68:69] op_sel_hi:[1,0,1] neg_lo:[1,0,0] neg_hi:[1,0,0]
    v_pk_fma_f32 v[70:71], v[102:103], v[122:123], v[70:71] op_sel_hi:[1,0,1] neg_lo:[1,0,0] neg_hi:[1,0,0]
    v_pk_mul_f32 v[68:69], v[68:69], v[116:117]
    v_pk_mul_f32 v[70:71], v[70:71], v[118:119]
    v_cvt_pk_bf16_f32 v52, v52, v68
    v_cvt_pk_bf16_f32 v53, v53, v69
    v_cvt_pk_bf16_f32 v54, v54, v70
    v_cvt_pk_bf16_f32 v55, v55, v71
    s_nop 1
    v_permlane16_swap_b32 v52, v54
    v_permlane16_swap_b32 v53, v55
    buffer_store_dwordx4 v[52:55], v12, s[4:7], s31 offen sc1
    v_pk_fma_f32 v[56:57], v[96:97], v[136:137], v[56:57] op_sel_hi:[1,0,1] neg_lo:[1,0,0] neg_hi:[1,0,0]
    v_pk_fma_f32 v[58:59], v[98:99], v[136:137], v[58:59] op_sel_hi:[1,0,1] neg_lo:[1,0,0] neg_hi:[1,0,0]
    v_pk_mul_f32 v[56:57], v[56:57], v[112:113]
    v_pk_mul_f32 v[58:59], v[58:59], v[114:115]
    v_pk_fma_f32 v[72:73], v[100:101], v[136:137], v[72:73] op_sel_hi:[1,0,1] neg_lo:[1,0,0] neg_hi:[1,0,0]
    v_pk_fma_f32 v[74:75], v[102:103], v[136:137], v[74:75] op_sel_hi:[1,0,1] neg_lo:[1,0,0] neg_hi:[1,0,0]
    v_pk_mul_f32 v[72:73], v[72:73], v[116:117]
    v_pk_mul_f32 v[74:75], v[74:75], v[118:119]
    v_cvt_pk_bf16_f32 v56, v56, v72
    v_cvt_pk_bf16_f32 v57, v57, v73
    v_cvt_pk_bf16_f32 v58, v58, v74
    v_cvt_pk_bf16_f32 v59, v59, v75
    s_nop 1
    v_permlane16_swap_b32 v56, v58
    v_permlane16_swap_b32 v57, v59
    buffer_store_dwordx4 v[56:59], v13, s[4:7], s31 offen sc1
    v_pk_fma_f32 v[60:61], v[96:97], v[138:139], v[60:61] op_sel_hi:[1,0,1] neg_lo:[1,0,0] neg_hi:[1,0,0]
    v_pk_fma_f32 v[62:63], v[98:99], v[138:139], v[62:63] op_sel_hi:[1,0,1] neg_lo:[1,0,0] neg_hi:[1,0,0]
    v_pk_mul_f32 v[60:61], v[60:61], v[112:113]
    v_pk_mul_f32 v[62:63], v[62:63], v[114:115]
    v_pk_fma_f32 v[76:77], v[100:101], v[138:139], v[76:77] op_sel_hi:[1,0,1] neg_lo:[1,0,0] neg_hi:[1,0,0]
    v_pk_fma_f32 v[78:79], v[102:103], v[138:139], v[78:79] op_sel_hi:[1,0,1] neg_lo:[1,0,0] neg_hi:[1,0,0]
    v_pk_mul_f32 v[76:77], v[76:77], v[116:117]
    v_pk_mul_f32 v[78:79], v[78:79], v[118:119]
    v_cvt_pk_bf16_f32 v60, v60, v76
    v_cvt_pk_bf16_f32 v61, v61, v77
    v_cvt_pk_bf16_f32 v62, v62, v78
    v_cvt_pk_bf16_f32 v63, v63, v79
    s_nop 1
    v_permlane16_swap_b32 v60, v62
    v_permlane16_swap_b32 v61, v63
    buffer_store_dwordx4 v[60:63], v14, s[4:7], s31 offen sc1
L_p0_sig:
    s_barrier
    s_mul_i32 s28, s45, 13120
    s_lshr_b32 s29, s28, 13
    s_add_u32 s28, s28, 12915
    s_lshr_b32 s28, s28, 13
    s_sub_u32 s28, s28, s29
    s_lshl_b32 s29, s29, 2
    s_and_b32 s30, s20, 3
    s_add_u32 s29, s29, s30
    s_lshl_b32 s29, s29, 7
    v_lshl_add_u32 v1, v0, 9, s29
    v_mov_b32 v2, 1
    s_lshl_b32 s28, 2, s28
    s_sub_u32 s28, s28, 1
    s_waitcnt vmcnt(0)
    s_mov_b32 exec_lo, s28
    s_mov_b32 exec_hi, 0
    buffer_atomic_add v2, v1, s[4:7], 0 offen sc1
    s_mov_b64 exec, -1
L_at:
    s_and_b32 s20, s2, 7
    s_lshl_b32 s20, s20, 2
    s_bfe_u32 s28, s2, 0x20003
    s_add_u32 s20, s20, s28
    s_lshr_b32 s21, s2, 5
    s_lshr_b32 s45, s92, 1
    s_mul_i32 s45, s45, 7864320
    s_add_u32 s45, s45, 7741440
    s_mul_i32 s46, s20, 163840
    s_add_u32 s46, s46, s45
    s_add_u32 s46, s46, 2621440
    s_cmp_lt_u32 s3, 8
    s_cbranch_scc1 L_at_comp
    s_setprio 3
    s_sub_u32 s22, s3, 8
    s_mul_i32 s26, s22, 81920
    v_lshlrev_b32 v1, 4, v0
    v_add_u32 v2, 4096, v1
    s_add_u32 s24, s46, s26
    s_mul_i32 s25, s21, 10240
    s_mul_i32 s28, s22, 20480
    s_add_u32 m0, s28, 61440
    s_cmp_eq_u32 s22, 0
    s_cselect_b32 s29, 4294926336, 0
    s_mov_b32 s23, 0
    s_lshr_b32 s28, s20, 1
    s_mul_i32 s30, s28, 40
    s_add_u32 s31, s30, 39
    s_lshr_b32 s30, s30, 6
    s_lshr_b32 s31, s31, 6
    s_sub_u32 s31, s31, s30
    s_mul_i32 s31, s31, 24
    s_add_u32 s31, s31, 24
    s_lshl_b32 s28, s28, 2
    s_cmp_eq_u32 s92, 0
    s_cselect_b32 s31, s31, 16
    s_cselect_b32 s30, 0, 960
    s_add_u32 s28, s28, s30
    s_cmp_eq_u32 s22, 0
    s_cbranch_scc0 L_at_poll_ok
    s_lshl_b32 s60, s28, 7
    s_add_u32 s58, s4, s60
    s_addc_u32 s59, s5, 0
    s_mov_b32 s61, 0
L_at_poll:
    s_mov_b32 s16, 0
    s_mov_b32 s17, 0
    s_mov_b32 s18, 0
    s_mov_b32 s19, 0
    s_atomic_add s16, s[58:59], 0 glc
    s_atomic_add s17, s[58:59], 128 glc
    s_atomic_add s18, s[58:59], 256 glc
    s_atomic_add s19, s[58:59], 384 glc
    s_add_u32 s61, s61, 1
    s_waitcnt lgkmcnt(0)
    s_min_u32 s16, s16, s17
    s_min_u32 s16, s16, s18
    s_min_u32 s16, s16, s19
    s_cmp_ge_u32 s16, s31
    s_cbranch_scc1 L_at_poll_ok
    s_cmp_lt_u32 s61, 200000
    s_cbranch_scc1 L_at_poll
L_at_poll_ok:
    s_barrier
L_at_q:
    s_mov_b32 s30, m0
    s_mul_i32 s28, s22, 5120
    s_mov_b32 m0, s28
    s_lshl_b32 s27, s20, 3
    s_add_u32 s27, s27, s21
    s_mul_i32 s27, s27, 10240
    s_add_u32 s27, s27, s28
    s_add_u32 s27, s27, s45
    buffer_load_dwordx4 v1, s[4:7], s27 offen offset:0 sc1 lds
    buffer_load_dwordx4 v1, s[4:7], s27 offen offset:1024 sc1 lds
    buffer_load_dwordx4 v1, s[4:7], s27 offen offset:2048 sc1 lds
    buffer_load_dwordx4 v1, s[4:7], s27 offen offset:3072 sc1 lds
    s_add_u32 m0, m0, 4096
    s_nop 0
    buffer_load_dwordx4 v2, s[4:7], s27 offen sc1 lds
    s_mov_b32 m0, s30
L_at_ld:
    s_add_u32 s27, s24, s25
    buffer_load_dwordx4 v1, s[4:7], s27 offen offset:0 sc1 lds
    buffer_load_dwordx4 v1, s[4:7], s27 offen offset:1024 sc1 lds
    buffer_load_dwordx4 v1, s[4:7], s27 offen offset:2048 sc1 lds
    buffer_load_dwordx4 v1, s[4:7], s27 offen offset:3072 sc1 lds
    s_add_u32 m0, m0, 4096
    s_add_u32 s25, s25, 5120
    buffer_load_dwordx4 v2, s[4:7], s27 offen sc1 lds
    s_add_u32 m0, m0, 1024
    s_cmp_eq_u32 s25, 81920
    s_cselect_b32 s25, 0, s25
    s_add_u32 s23, s23, 1
    s_and_b32 s28, s23, 3
    s_cmp_eq_u32 s28, 0
    s_cselect_b32 s28, s29, 0
    s_add_u32 m0, m0, s28
    s_cmp_eq_u32 s23, 1
    s_cbranch_scc0 L_at_ld1
    s_waitcnt vmcnt(0)
    s_barrier
L_at_ld1:
    s_cmp_eq_u32 s23, 4
    s_cbranch_scc0 L_at_ld2
    s_waitcnt vmcnt(5)
    s_barrier
L_at_ld2:
    s_cmp_lt_u32 s23, 16
    s_cbranch_scc1 L_at_ld
    s_waitcnt vmcnt(0)
    s_barrier
    s_cmp_eq_u32 s92, 0
    s_cbranch_scc0 L_pack_end
    v_and_b32 v5, 3, v0
    s_mov_b32 s15, 0x20000
    s_mov_b32 s44, 0
    s_cmp_eq_u32 s3, 9
    s_cbranch_scc1 L_pack_wo0
    s_cmp_ge_u32 s2, 128
    s_cselect_b32 s28, 32, 8
    s_load_dwordx2 s[12:13], s[0:1], s28
    s_mov_b32 s14, 2457600
    s_bfe_u32 s24, s2, 0x40003
    s_and_b32 s25, s2, 7
    s_mul_i32 s28, s24, 40
    s_cmp_ge_u32 s25, 5
    s_cbranch_scc1 L_pack_v
    v_lshrrev_b32 v3, 1, v5
    v_mul_u32_u24 v3, 640, v3
    v_and_b32 v4, 1, v5
    v_mad_u32_u24 v3, v4, 20, v3
    s_lshl_b32 s29, s25, 2
    s_add_u32 s28, s28, s29
    v_add_u32 v3, s28, v3
    s_branch L_pack_q
L_pack_v:
    s_lshl_b32 s29, s25, 4
    s_sub_u32 s29, s29, 80
    v_lshl_add_u32 v4, v5, 2, s29
    v_cmp_le_u32 s[38:39], 40, v4
    s_add_u32 s28, s28, 1280
    v_add_u32 v3, s28, v4
    v_mov_b32 v4, 1073709056
    v_cndmask_b32 v3, v3, v4, s[38:39]
    s_cmp_lt_u32 s2, 128
    s_cselect_b32 s44, 1, 0
L_pack_q:
    s_mov_b32 s26, 3840
    s_lshr_b32 s47, s2, 3
    s_mul_i32 s27, s47, 163840
    s_add_u32 s27, s27, 860160
    s_add_u32 s47, s47, 1040
    s_lshl_b32 s28, s25, 10
    s_add_u32 s27, s27, s28
    s_mov_b32 s30, 8192
    s_mov_b32 s35, 61440
    s_mov_b32 s46, 0
    s_mov_b32 s31, 0
    s_mov_b32 s23, 4
    s_mov_b32 s45, 512
    s_branch L_pack_go
L_pack_wo0:
    s_mov_b32 s45, s2
L_pack_wo:
    s_lshr_b32 s24, s45, 2
    s_cmp_ge_u32 s24, 40
    s_cselect_b32 s28, 40, 16
    s_load_dwordx2 s[12:13], s[0:1], s28
    s_mov_b32 s14, 819200
    s_mul_i32 s25, s24, 205
    s_lshr_b32 s25, s25, 10
    s_add_u32 s47, s25, 1024
    s_mul_i32 s28, s25, 5
    s_sub_u32 s24, s24, s28
    s_mul_i32 s27, s25, 102400
    s_add_u32 s27, s27, 6103040
    s_lshl_b32 s28, s24, 10
    s_add_u32 s27, s27, s28
    s_and_b32 s31, s45, 3
    s_mul_i32 s28, s31, 25600
    s_add_u32 s27, s27, s28
    s_mul_i32 s46, s31, 10
    s_mul_i32 s31, s31, 256000
    s_and_b32 s25, s25, 7
    s_mul_i32 s28, s25, 80
    s_lshr_b32 s29, s24, 1
    s_lshl_b32 s29, s29, 5
    s_add_u32 s28, s28, s29
    s_and_b32 s29, s24, 1
    s_lshl_b32 s29, s29, 2
    s_add_u32 s28, s28, s29
    s_cmp_eq_u32 s24, 4
    s_cselect_b32 s29, 2, 3
    v_lshlrev_b32 v3, s29, v5
    v_add_u32 v3, s28, v3
    s_mov_b32 s26, 1280
    s_mov_b32 s35, 25600
    s_mov_b32 s30, 5120
    s_mov_b32 s23, 1
L_pack_go:
    v_lshlrev_b32 v3, 1, v3
    v_and_b32 v6, -16, v3
    v_lshrrev_b32 v4, 2, v0
    v_mad_u32_u24 v6, v4, s26, v6
    v_and_b32 v7, 8, v3
    v_lshl_add_u32 v7, v5, 4, v7
    v_and_b32 v3, 3, v4
    v_lshl_add_u32 v7, v3, 6, v7
    v_lshrrev_b32 v3, 4, v0
    v_lshl_add_u32 v7, v3, 9, v7
    s_sub_u32 s33, s3, 8
    s_mul_i32 s33, s33, 20480
    s_add_u32 s33, s33, 61440
    v_add_u32 v7, s33, v7
    v_lshrrev_b32 v3, 2, v4
    v_lshlrev_b32 v3, 4, v3
    v_add_u32 v3, 16, v3
    v_mad_u32_u24 v38, v3, s26, v6
    v_mov_b32 v8, 0
    v_mov_b32 v12, 1065369472
    v_mov_b32 v9, 0
    v_mov_b32 v13, 1065369472
    v_mov_b32 v10, 0
    v_mov_b32 v14, 1065369472
    v_mov_b32 v11, 0
    v_mov_b32 v15, 1065369472
    s_waitcnt lgkmcnt(0)
L_pack_loop:
    s_mov_b32 m0, s33
    s_nop 0
    buffer_load_dwordx4 v6, s[12:15], s31 offen lds
    s_add_u32 m0, m0, 1024
    s_add_u32 s31, s31, s35
    buffer_load_dwordx4 v6, s[12:15], s31 offen lds
    s_add_u32 m0, m0, 1024
    s_add_u32 s31, s31, s35
    s_cmp_eq_u32 s46, 30
    s_cbranch_scc0 L_pack_r0
    v_mov_b32 v6, v38
    s_mov_b32 s31, 0
    s_mov_b32 s35, 102400
L_pack_r0:
    buffer_load_dwordx4 v6, s[12:15], s31 offen lds
    s_add_u32 m0, m0, 1024
    s_add_u32 s31, s31, s35
    buffer_load_dwordx4 v6, s[12:15], s31 offen lds
    s_add_u32 m0, m0, 1024
    s_add_u32 s31, s31, s35
    buffer_load_dwordx4 v6, s[12:15], s31 offen lds
    s_add_u32 m0, m0, 1024
    s_add_u32 s31, s31, s35
    buffer_load_dwordx4 v6, s[12:15], s31 offen lds
    s_add_u32 m0, m0, 1024
    s_add_u32 s31, s31, s35
    buffer_load_dwordx4 v6, s[12:15], s31 offen lds
    s_add_u32 m0, m0, 1024
    s_add_u32 s31, s31, s35
    buffer_load_dwordx4 v6, s[12:15], s31 offen lds
    s_add_u32 m0, m0, 1024
    s_add_u32 s31, s31, s35
    buffer_load_dwordx4 v6, s[12:15], s31 offen lds
    s_add_u32 m0, m0, 1024
    s_add_u32 s31, s31, s35
    buffer_load_dwordx4 v6, s[12:15], s31 offen lds
    s_add_u32 m0, m0, 1024
    s_add_u32 s31, s31, s35
    s_waitcnt vmcnt(0)
    ds_read_b64_tr_b16 v[16:17], v7 offset:0
    ds_read_b64_tr_b16 v[18:19], v7 offset:256
    ds_read_b64_tr_b16 v[20:21], v7 offset:2048
    ds_read_b64_tr_b16 v[22:23], v7 offset:2304
    ds_read_b64_tr_b16 v[24:25], v7 offset:4096
    ds_read_b64_tr_b16 v[26:27], v7 offset:4352
    ds_read_b64_tr_b16 v[28:29], v7 offset:6144
    ds_read_b64_tr_b16 v[30:31], v7 offset:6400
    ds_read_b64_tr_b16 v[32:33], v7 offset:8192
    ds_read_b64_tr_b16 v[34:35], v7 offset:8448
    s_waitcnt lgkmcnt(0)
    buffer_store_dwordx4 v[16:19], v1, s[4:7], s27 offen sc1
    s_add_u32 s27, s27, s30
    buffer_store_dwordx4 v[20:23], v1, s[4:7], s27 offen sc1
    s_add_u32 s27, s27, s30
    buffer_store_dwordx4 v[24:27], v1, s[4:7], s27 offen sc1
    s_add_u32 s27, s27, s30
    buffer_store_dwordx4 v[28:31], v1, s[4:7], s27 offen sc1
    s_add_u32 s27, s27, s30
    buffer_store_dwordx4 v[32:35], v1, s[4:7], s27 offen sc1
    s_add_u32 s27, s27, s30
    s_cmp_eq_u32 s44, 1
    s_cbranch_scc1 L_pack_mf
    v_mfma_f32_16x16x32_bf16 v[8:11], v[16:19], v[12:15], v[8:11]
    v_mfma_f32_16x16x32_bf16 v[8:11], v[20:23], v[12:15], v[8:11]
    v_mfma_f32_16x16x32_bf16 v[8:11], v[24:27], v[12:15], v[8:11]
    v_mfma_f32_16x16x32_bf16 v[8:11], v[28:31], v[12:15], v[8:11]
    v_mfma_f32_16x16x32_bf16 v[8:11], v[32:35], v[12:15], v[8:11]
    s_branch L_pack_md
L_pack_mf:
    v_mfma_f32_16x16x32_bf16 v[8:11], v[12:15], v[16:19], v[8:11]
    v_mfma_f32_16x16x32_bf16 v[8:11], v[12:15], v[20:23], v[8:11]
    v_mfma_f32_16x16x32_bf16 v[8:11], v[12:15], v[24:27], v[8:11]
    v_mfma_f32_16x16x32_bf16 v[8:11], v[12:15], v[28:31], v[8:11]
    v_mfma_f32_16x16x32_bf16 v[8:11], v[12:15], v[32:35], v[8:11]
L_pack_md:
    s_sub_u32 s23, s23, 1
    s_cmp_lg_u32 s23, 0
    s_cbranch_scc1 L_pack_loop
    s_cmp_eq_u32 s3, 9
    s_cbranch_scc1 L_pack_sig
    s_lshr_b32 s28, s2, 5
    s_mul_i32 s28, s28, 40960
    s_bfe_u32 s29, s2, 0x20003
    s_mul_i32 s29, s29, 5120
    s_add_u32 s28, s28, s29
    s_and_b32 s29, s2, 1
    s_mul_i32 s29, s29, 20480
    s_add_u32 s28, s28, s29
    s_bfe_u32 s29, s2, 0x20001
    s_lshl_b32 s29, s29, 10
    s_add_u32 s28, s28, s29
    s_add_u32 s28, s28, 532480
    buffer_store_dwordx4 v[8:11], v1, s[4:7], s28 offen sc1
L_pack_sig:
    s_lshl_b32 s60, s47, 7
    v_mul_u32_u24 v36, 139264, v0
    v_add_u32 v36, s60, v36
    v_mov_b32 v37, 1
    s_waitcnt vmcnt(0)
    s_mov_b64 exec, 1
    buffer_atomic_add v37, v36, s[4:7], 0 offen sc1
    s_mov_b64 exec, -1
    s_add_u32 s45, s45, 256
    s_cmp_lt_u32 s45, 320
    s_cbranch_scc1 L_pack_wo
L_pack_end:
    s_barrier
    s_and_b32 s25, s2, 1
    s_lshl_b32 s25, s25, 2
    s_lshr_b32 s30, s2, 6
    s_add_u32 s25, s25, s30
    s_add_u32 s26, s25, 1024
    s_lshl_b32 s60, s26, 7
    s_add_u32 s58, s4, s60
    s_addc_u32 s59, s5, 0
    s_mov_b32 s61, 0
L_at_w2_pp:
    s_mov_b32 s16, 0
    s_atomic_add s16, s[58:59], 0 glc
    s_add_u32 s61, s61, 1
    s_waitcnt lgkmcnt(0)
    s_cmp_ge_u32 s16, 20
    s_cbranch_scc1 L_at_w2_pp_ok
    s_cmp_lt_u32 s61, 200000
    s_cbranch_scc1 L_at_w2_pp
L_at_w2_pp_ok:
    s_sub_u32 s28, s3, 8
    s_mul_i32 s28, s28, 51200
    s_mul_i32 s24, s25, 102400
    s_add_u32 s24, s24, s28
    s_add_u32 s24, s24, 6103040
    s_add_u32 m0, s28, 20480
    s_mov_b32 s23, 5
L_at_w2:
    buffer_load_dwordx4 v1, s[4:7], s24 offen offset:0 sc1 lds
    buffer_load_dwordx4 v1, s[4:7], s24 offen offset:1024 sc1 lds
    buffer_load_dwordx4 v1, s[4:7], s24 offen offset:2048 sc1 lds
    buffer_load_dwordx4 v1, s[4:7], s24 offen offset:3072 sc1 lds
    s_add_u32 m0, m0, 4096
    s_add_u32 s24, s24, 4096
    buffer_load_dwordx4 v1, s[4:7], s24 offen offset:0 sc1 lds
    buffer_load_dwordx4 v1, s[4:7], s24 offen offset:1024 sc1 lds
    buffer_load_dwordx4 v1, s[4:7], s24 offen offset:2048 sc1 lds
    buffer_load_dwordx4 v1, s[4:7], s24 offen offset:3072 sc1 lds
    s_add_u32 m0, m0, 4096
    s_add_u32 s24, s24, 4096
    buffer_load_dwordx4 v1, s[4:7], s24 offen offset:0 sc1 lds
    buffer_load_dwordx4 v1, s[4:7], s24 offen offset:1024 sc1 lds
    s_add_u32 m0, m0, 2048
    s_add_u32 s24, s24, 2048
    s_sub_u32 s23, s23, 1
    s_cmp_lg_u32 s23, 0
    s_cbranch_scc1 L_at_w2
    s_and_b32 s25, s2, 1
    s_lshl_b32 s25, s25, 3
    s_lshr_b32 s30, s2, 5
    s_add_u32 s25, s25, s30
    s_add_u32 s26, s25, 1056
    s_lshl_b32 s60, s26, 7
    s_add_u32 s58, s4, s60
    s_addc_u32 s59, s5, 0
    s_mov_b32 s61, 0
L_at_pq:
    s_mov_b32 s16, 0
    s_atomic_add s16, s[58:59], 0 glc
    s_add_u32 s61, s61, 1
    s_waitcnt lgkmcnt(0)
    s_cmp_ge_u32 s16, 8
    s_cbranch_scc1 L_at_pq_ok
    s_cmp_lt_u32 s61, 200000
    s_cbranch_scc1 L_at_pq
L_at_pq_ok:
    s_sub_u32 s28, s3, 8
    s_mul_i32 s28, s28, 16384
    s_mul_i32 s24, s25, 163840
    s_add_u32 s24, s24, s28
    s_bfe_u32 s28, s2, 0x20003
    s_mul_i32 s28, s28, 40960
    s_add_u32 s24, s24, s28
    s_add_u32 s24, s24, 3481600
    v_lshlrev_b32 v6, 7, v0
    buffer_load_dword v7, v6, s[4:7], s24 offen
    s_add_u32 s24, s24, 8192
    buffer_load_dword v7, v6, s[4:7], s24 offen
    s_add_u32 s24, s24, 8192
    buffer_load_dword v7, v6, s[4:7], s24 offen
    s_add_u32 s24, s24, 8192
    s_setprio 0
    s_barrier
    s_branch L_g2
L_at_comp:
    s_and_b32 s36, s3, 3
    s_lshr_b32 s37, s3, 2
    s_lshl_b32 s29, s21, 3
    s_lshl_b32 s30, s36, 1
    s_add_u32 s29, s29, s30
    s_and_b32 s30, s20, 1
    v_and_b32 v1, 31, v0
    v_lshlrev_b32 v8, 3, v1
    v_lshlrev_b32 v7, 3, v0
    v_add_u32 v8, 1024, v8
    v_lshrrev_b32 v2, 5, v0
    v_mul_u32_u24 v9, 320, v2
    v_lshl_add_u32 v9, v1, 4, v9
    v_add_u32 v9, 1280, v9
    s_mov_b32 s34, 0x000fffff
    s_mov_b32 s35, 0x000fffff
    s_add_u32 s29, s29, s37
    s_lshl_b32 s42, s92, 6
    s_add_u32 s42, s42, s29
    s_lshl_b32 s42, s42, 1
    s_add_u32 s42, s42, s30
    s_add_u32 s42, s42, 64
    v_and_b32 v3, 1, v0
    v_mul_u32_u24 v12, 20480, v3
    v_lshrrev_b32 v3, 1, v1
    v_lshl_add_u32 v11, v3, 4, v12
    v_lshl_add_u32 v11, v2, 8, v11
    v_lshl_add_u32 v12, v3, 3, v12
    s_mul_i32 s29, s29, 40960
    s_mul_i32 s33, s92, 2621440
    s_add_u32 s29, s29, s33
    s_add_u32 s29, s29, 23470080
    s_lshl_b32 s33, s20, 9
    s_add_u32 s33, s33, s29
    s_lshl_b32 s39, s20, 7
    s_add_u32 s39, s39, s29
    s_add_u32 s39, s39, 16384
    s_cmp_eq_u32 s37, 0
    s_mov_b32 s38, 20480
    s_cmov_b32 s38, 4294946816
    s_mul_i32 s31, s37, 20480
    s_add_u32 s31, s31, 61440
    v_cmp_eq_u32 vcc, 20, v1
    v_mov_b32 v5, 1065369472
    v_mov_b32 v4, v7
    v_add_u32 v7, s31, v7
    v_add_u32 v8, s31, v8
    v_add_u32 v9, s31, v9
    v_cndmask_b32 v5, 0, v5, vcc
    v_mov_b32 v64, 0
    v_mov_b32 v80, 0
    v_mov_b32 v65, 0
    v_mov_b32 v81, 0
    v_mov_b32 v66, 0
    v_mov_b32 v82, 0
    v_mov_b32 v67, 0
    v_mov_b32 v83, 0
    v_mov_b32 v68, 0
    v_mov_b32 v84, 0
    v_mov_b32 v69, 0
    v_mov_b32 v85, 0
    v_mov_b32 v70, 0
    v_mov_b32 v86, 0
    v_mov_b32 v71, 0
    v_mov_b32 v87, 0
    v_mov_b32 v72, 0
    v_mov_b32 v88, 0
    v_mov_b32 v73, 0
    v_mov_b32 v89, 0
    v_mov_b32 v74, 0
    v_mov_b32 v90, 0
    v_mov_b32 v75, 0
    v_mov_b32 v91, 0
    v_mov_b32 v76, 0
    v_mov_b32 v92, 0
    v_mov_b32 v77, 0
    v_mov_b32 v93, 0
    v_mov_b32 v78, 0
    v_mov_b32 v94, 0
    v_mov_b32 v79, 0
    v_mov_b32 v95, 0
    v_mov_b32 v116, v5
    v_mov_b32 v124, v5
    v_mov_b32 v117, v5
    v_mov_b32 v125, v5
    v_mov_b32 v118, v5
    v_mov_b32 v126, v5
    v_mov_b32 v119, v5
    v_mov_b32 v127, v5
    v_mov_b32 v120, v5
    v_mov_b32 v128, v5
    v_mov_b32 v121, v5
    v_mov_b32 v129, v5
    v_mov_b32 v122, v5
    v_mov_b32 v130, v5
    v_mov_b32 v123, v5
    v_mov_b32 v131, v5
    v_mov_b32 v100, 0
    v_mov_b32 v101, 0
    v_mov_b32 v102, 0
    v_mov_b32 v103, 0
    s_mul_i32 s30, s3, 3072
    s_add_u32 s30, s30, 122880
    s_xor_b32 s29, s3, 4
    s_mul_i32 s29, s29, 3072
    s_add_u32 s29, s29, 122880
    v_lshlrev_b32 v13, 4, v0
    v_add_u32 v14, s29, v13
    v_add_u32 v13, s30, v13
    s_mov_b32 s28, 0x1f800000
    s_mov_b32 s43, 0x5f800000
    s_mov_b32 s31, s28
    v_mov_b64 v[28:29], 0
    v_mov_b64 v[30:31], 0
    s_mul_i32 s28, s36, 2560
    v_add_u32 v4, s28, v4
    s_setprio 3
    s_barrier
    s_barrier
    ds_read2st64_b64 v[20:23], v4 offset0:0 offset1:1
    s_mov_b32 exec_hi, 0
    ds_read_b64 v[28:29], v4 offset:1024
    s_mov_b32 exec_hi, -1
    ds_read2st64_b64 v[104:107], v7 offset0:0 offset1:1
    ds_read_b64 v[112:113], v8 offset:0
    ds_read_b64 v[24:25], v4 offset:1280
    ds_read_b64 v[26:27], v4 offset:1792
    s_mov_b32 exec_hi, 0
    ds_read_b64 v[30:31], v4 offset:2304
    s_mov_b32 exec_hi, -1
    s_mov_b64 exec, s[34:35]
    ds_read_b128 v[116:119], v9 offset:0
    ds_read_b128 v[120:123], v9 offset:640
    s_mov_b64 exec, -1
    s_waitcnt lgkmcnt(5)
    v_mfma_f32_32x32x16_bf16 v[32:47], v[104:107], v[20:23], 0
    v_mfma_f32_32x32x8_bf16 v[32:47], v[112:113], v[28:29], v[32:47]
    s_mov_b32 s23, 0
    s_waitcnt lgkmcnt(2)
    s_nop 7
    s_nop 1
.p2align 4
L_at_loop:
    v_exp_f32 v32, v32
    v_exp_f32 v33, v33
    v_mfma_f32_32x32x16_bf16 v[80:95], v[128:131], v[100:103], v[80:95]
    v_exp_f32 v34, v34
    v_exp_f32 v35, v35
    v_cvt_pk_bf16_f32 v96, v32, v33
    v_cvt_pk_bf16_f32 v97, v34, v35
    v_mfma_f32_32x32x16_bf16 v[48:63], v[104:107], v[24:27], 0
    ds_read2st64_b64 v[108:111], v7 offset0:5 offset1:6
    ds_read_b64 v[114:115], v8 offset:2560
    v_exp_f32 v36, v36
    v_exp_f32 v37, v37
    v_exp_f32 v38, v38
    v_exp_f32 v39, v39
    v_cvt_pk_bf16_f32 v98, v36, v37
    v_cvt_pk_bf16_f32 v99, v38, v39
    v_mfma_f32_32x32x8_bf16 v[48:63], v[112:113], v[30:31], v[48:63]
    v_exp_f32 v40, v40
    v_exp_f32 v41, v41
    v_exp_f32 v42, v42
    v_exp_f32 v43, v43
    v_cvt_pk_bf16_f32 v100, v40, v41
    v_cvt_pk_bf16_f32 v101, v42, v43
    s_waitcnt lgkmcnt(2)
    v_mfma_f32_32x32x16_bf16 v[64:79], v[116:119], v[96:99], v[64:79]
    s_mov_b64 exec, s[34:35]
    ds_read_b128 v[124:127], v9 offset:2560
    ds_read_b128 v[128:131], v9 offset:3200
    s_mov_b64 exec, -1
    v_exp_f32 v44, v44
    v_exp_f32 v45, v45
    v_exp_f32 v46, v46
    v_exp_f32 v47, v47
    v_cvt_pk_bf16_f32 v102, v44, v45
    v_cvt_pk_bf16_f32 v103, v46, v47
    v_exp_f32 v48, v48
    v_exp_f32 v49, v49
    v_mfma_f32_32x32x16_bf16 v[64:79], v[120:123], v[100:103], v[64:79]
    v_exp_f32 v50, v50
    v_exp_f32 v51, v51
    v_cvt_pk_bf16_f32 v96, v48, v49
    v_cvt_pk_bf16_f32 v97, v50, v51
    s_waitcnt lgkmcnt(2)
    v_mfma_f32_32x32x16_bf16 v[32:47], v[108:111], v[20:23], 0
    v_exp_f32 v52, v52
    v_exp_f32 v53, v53
    v_exp_f32 v54, v54
    v_exp_f32 v55, v55
    v_cvt_pk_bf16_f32 v98, v52, v53
    v_cvt_pk_bf16_f32 v99, v54, v55
    v_mfma_f32_32x32x8_bf16 v[32:47], v[114:115], v[28:29], v[32:47]
    v_exp_f32 v56, v56
    v_exp_f32 v57, v57
    v_exp_f32 v58, v58
    v_exp_f32 v59, v59
    v_cvt_pk_bf16_f32 v100, v56, v57
    v_cvt_pk_bf16_f32 v101, v58, v59
    v_mfma_f32_32x32x16_bf16 v[80:95], v[116:119], v[96:99], v[80:95]
    v_exp_f32 v60, v60
    v_exp_f32 v61, v61
    v_exp_f32 v62, v62
    v_exp_f32 v63, v63
    v_cvt_pk_bf16_f32 v102, v60, v61
    v_cvt_pk_bf16_f32 v103, v62, v63
    s_cmp_eq_u32 s23, 0
    s_cbranch_scc0 L_at_nc1
    s_barrier
L_at_nc1:
    v_exp_f32 v32, v32
    v_exp_f32 v33, v33
    v_mfma_f32_32x32x16_bf16 v[80:95], v[120:123], v[100:103], v[80:95]
    v_exp_f32 v34, v34
    v_exp_f32 v35, v35
    v_cvt_pk_bf16_f32 v96, v32, v33
    v_cvt_pk_bf16_f32 v97, v34, v35
    v_mfma_f32_32x32x16_bf16 v[48:63], v[108:111], v[24:27], 0
    ds_read2st64_b64 v[104:107], v7 offset0:10 offset1:11
    ds_read_b64 v[112:113], v8 offset:5120
    v_exp_f32 v36, v36
    v_exp_f32 v37, v37
    v_exp_f32 v38, v38
    v_exp_f32 v39, v39
    v_cvt_pk_bf16_f32 v98, v36, v37
    v_cvt_pk_bf16_f32 v99, v38, v39
    v_mfma_f32_32x32x8_bf16 v[48:63], v[114:115], v[30:31], v[48:63]
    v_exp_f32 v40, v40
    v_exp_f32 v41, v41
    v_exp_f32 v42, v42
    v_exp_f32 v43, v43
    v_cvt_pk_bf16_f32 v100, v40, v41
    v_cvt_pk_bf16_f32 v101, v42, v43
    s_waitcnt lgkmcnt(2)
    v_mfma_f32_32x32x16_bf16 v[64:79], v[124:127], v[96:99], v[64:79]
    s_mov_b64 exec, s[34:35]
    ds_read_b128 v[116:119], v9 offset:5120
    ds_read_b128 v[120:123], v9 offset:5760
    s_mov_b64 exec, -1
    v_exp_f32 v44, v44
    v_exp_f32 v45, v45
    v_exp_f32 v46, v46
    v_exp_f32 v47, v47
    v_cvt_pk_bf16_f32 v102, v44, v45
    v_cvt_pk_bf16_f32 v103, v46, v47
    v_exp_f32 v48, v48
    v_exp_f32 v49, v49
    v_mfma_f32_32x32x16_bf16 v[64:79], v[128:131], v[100:103], v[64:79]
    v_exp_f32 v50, v50
    v_exp_f32 v51, v51
    v_cvt_pk_bf16_f32 v96, v48, v49
    v_cvt_pk_bf16_f32 v97, v50, v51
    s_waitcnt lgkmcnt(2)
    v_mfma_f32_32x32x16_bf16 v[32:47], v[104:107], v[20:23], 0
    v_exp_f32 v52, v52
    v_exp_f32 v53, v53
    v_exp_f32 v54, v54
    v_exp_f32 v55, v55
    v_cvt_pk_bf16_f32 v98, v52, v53
    v_cvt_pk_bf16_f32 v99, v54, v55
    v_mfma_f32_32x32x8_bf16 v[32:47], v[112:113], v[28:29], v[32:47]
    v_exp_f32 v56, v56
    v_exp_f32 v57, v57
    v_exp_f32 v58, v58
    v_exp_f32 v59, v59
    v_cvt_pk_bf16_f32 v100, v56, v57
    v_cvt_pk_bf16_f32 v101, v58, v59
    v_mfma_f32_32x32x16_bf16 v[80:95], v[124:127], v[96:99], v[80:95]
    v_exp_f32 v60, v60
    v_exp_f32 v61, v61
    v_exp_f32 v62, v62
    v_exp_f32 v63, v63
    v_cvt_pk_bf16_f32 v102, v60, v61
    v_cvt_pk_bf16_f32 v103, v62, v63
    s_cmp_eq_u32 s23, 3
    s_cbranch_scc0 L_at_nc2
    s_barrier
L_at_nc2:
    v_exp_f32 v32, v32
    v_exp_f32 v33, v33
    v_mfma_f32_32x32x16_bf16 v[80:95], v[128:131], v[100:103], v[80:95]
    v_exp_f32 v34, v34
    v_exp_f32 v35, v35
    v_cvt_pk_bf16_f32 v96, v32, v33
    v_cvt_pk_bf16_f32 v97, v34, v35
    v_mfma_f32_32x32x16_bf16 v[48:63], v[104:107], v[24:27], 0
    ds_read2st64_b64 v[108:111], v7 offset0:15 offset1:16
    ds_read_b64 v[114:115], v8 offset:7680
    v_exp_f32 v36, v36
    v_exp_f32 v37, v37
    v_exp_f32 v38, v38
    v_exp_f32 v39, v39
    v_cvt_pk_bf16_f32 v98, v36, v37
    v_cvt_pk_bf16_f32 v99, v38, v39
    v_mfma_f32_32x32x8_bf16 v[48:63], v[112:113], v[30:31], v[48:63]
    v_exp_f32 v40, v40
    v_exp_f32 v41, v41
    v_exp_f32 v42, v42
    v_exp_f32 v43, v43
    v_cvt_pk_bf16_f32 v100, v40, v41
    v_cvt_pk_bf16_f32 v101, v42, v43
    s_waitcnt lgkmcnt(2)
    v_mfma_f32_32x32x16_bf16 v[64:79], v[116:119], v[96:99], v[64:79]
    s_mov_b64 exec, s[34:35]
    ds_read_b128 v[124:127], v9 offset:7680
    ds_read_b128 v[128:131], v9 offset:8320
    s_mov_b64 exec, -1
    v_exp_f32 v44, v44
    v_exp_f32 v45, v45
    v_exp_f32 v46, v46
    v_exp_f32 v47, v47
    v_cvt_pk_bf16_f32 v102, v44, v45
    v_cvt_pk_bf16_f32 v103, v46, v47
    v_exp_f32 v48, v48
    v_exp_f32 v49, v49
    v_mfma_f32_32x32x16_bf16 v[64:79], v[120:123], v[100:103], v[64:79]
    v_exp_f32 v50, v50
    v_exp_f32 v51, v51
    v_cvt_pk_bf16_f32 v96, v48, v49
    v_cvt_pk_bf16_f32 v97, v50, v51
    s_waitcnt lgkmcnt(2)
    v_mfma_f32_32x32x16_bf16 v[32:47], v[108:111], v[20:23], 0
    v_exp_f32 v52, v52
    v_exp_f32 v53, v53
    v_exp_f32 v54, v54
    v_exp_f32 v55, v55
    v_cvt_pk_bf16_f32 v98, v52, v53
    v_cvt_pk_bf16_f32 v99, v54, v55
    v_mfma_f32_32x32x8_bf16 v[32:47], v[114:115], v[28:29], v[32:47]
    v_exp_f32 v56, v56
    v_exp_f32 v57, v57
    v_exp_f32 v58, v58
    v_exp_f32 v59, v59
    v_cvt_pk_bf16_f32 v100, v56, v57
    v_cvt_pk_bf16_f32 v101, v58, v59
    v_mfma_f32_32x32x16_bf16 v[80:95], v[116:119], v[96:99], v[80:95]
    v_exp_f32 v60, v60
    v_exp_f32 v61, v61
    v_exp_f32 v62, v62
    v_exp_f32 v63, v63
    v_cvt_pk_bf16_f32 v102, v60, v61
    v_cvt_pk_bf16_f32 v103, v62, v63
    v_exp_f32 v32, v32
    v_exp_f32 v33, v33
    v_mfma_f32_32x32x16_bf16 v[80:95], v[120:123], v[100:103], v[80:95]
    v_exp_f32 v34, v34
    v_exp_f32 v35, v35
    v_cvt_pk_bf16_f32 v96, v32, v33
    v_cvt_pk_bf16_f32 v97, v34, v35
    v_mfma_f32_32x32x16_bf16 v[48:63], v[108:111], v[24:27], 0
    ds_read2st64_b64 v[104:107], v7 offset0:20 offset1:21
    ds_read_b64 v[112:113], v8 offset:10240
    v_exp_f32 v36, v36
    v_exp_f32 v37, v37
    v_exp_f32 v38, v38
    v_exp_f32 v39, v39
    v_cvt_pk_bf16_f32 v98, v36, v37
    v_cvt_pk_bf16_f32 v99, v38, v39
    v_mfma_f32_32x32x8_bf16 v[48:63], v[114:115], v[30:31], v[48:63]
    v_exp_f32 v40, v40
    v_exp_f32 v41, v41
    v_exp_f32 v42, v42
    v_exp_f32 v43, v43
    v_cvt_pk_bf16_f32 v100, v40, v41
    v_cvt_pk_bf16_f32 v101, v42, v43
    s_waitcnt lgkmcnt(2)
    v_mfma_f32_32x32x16_bf16 v[64:79], v[124:127], v[96:99], v[64:79]
    s_mov_b64 exec, s[34:35]
    ds_read_b128 v[116:119], v9 offset:10240
    ds_read_b128 v[120:123], v9 offset:10880
    s_mov_b64 exec, -1
    v_exp_f32 v44, v44
    v_exp_f32 v45, v45
    v_exp_f32 v46, v46
    v_exp_f32 v47, v47
    v_cvt_pk_bf16_f32 v102, v44, v45
    v_cvt_pk_bf16_f32 v103, v46, v47
    v_exp_f32 v48, v48
    v_exp_f32 v49, v49
    v_mfma_f32_32x32x16_bf16 v[64:79], v[128:131], v[100:103], v[64:79]
    v_exp_f32 v50, v50
    v_exp_f32 v51, v51
    v_cvt_pk_bf16_f32 v96, v48, v49
    v_cvt_pk_bf16_f32 v97, v50, v51
    s_waitcnt lgkmcnt(2)
    v_mfma_f32_32x32x16_bf16 v[32:47], v[104:107], v[20:23], 0
    v_exp_f32 v52, v52
    v_exp_f32 v53, v53
    v_exp_f32 v54, v54
    v_exp_f32 v55, v55
    v_cvt_pk_bf16_f32 v98, v52, v53
    v_cvt_pk_bf16_f32 v99, v54, v55
    v_mfma_f32_32x32x8_bf16 v[32:47], v[112:113], v[28:29], v[32:47]
    v_exp_f32 v56, v56
    v_exp_f32 v57, v57
    v_exp_f32 v58, v58
    v_exp_f32 v59, v59
    v_cvt_pk_bf16_f32 v100, v56, v57
    v_cvt_pk_bf16_f32 v101, v58, v59
    v_mfma_f32_32x32x16_bf16 v[80:95], v[124:127], v[96:99], v[80:95]
    v_exp_f32 v60, v60
    v_exp_f32 v61, v61
    v_exp_f32 v62, v62
    v_exp_f32 v63, v63
    v_cvt_pk_bf16_f32 v102, v60, v61
    v_cvt_pk_bf16_f32 v103, v62, v63
    v_exp_f32 v32, v32
    v_exp_f32 v33, v33
    v_mfma_f32_32x32x16_bf16 v[80:95], v[128:131], v[100:103], v[80:95]
    v_exp_f32 v34, v34
    v_exp_f32 v35, v35
    v_cvt_pk_bf16_f32 v96, v32, v33
    v_cvt_pk_bf16_f32 v97, v34, v35
    v_mfma_f32_32x32x16_bf16 v[48:63], v[104:107], v[24:27], 0
    ds_read2st64_b64 v[108:111], v7 offset0:25 offset1:26
    ds_read_b64 v[114:115], v8 offset:12800
    v_exp_f32 v36, v36
    v_exp_f32 v37, v37
    v_exp_f32 v38, v38
    v_exp_f32 v39, v39
    v_cvt_pk_bf16_f32 v98, v36, v37
    v_cvt_pk_bf16_f32 v99, v38, v39
    v_mfma_f32_32x32x8_bf16 v[48:63], v[112:113], v[30:31], v[48:63]
    v_exp_f32 v40, v40
    v_exp_f32 v41, v41
    v_exp_f32 v42, v42
    v_exp_f32 v43, v43
    v_cvt_pk_bf16_f32 v100, v40, v41
    v_cvt_pk_bf16_f32 v101, v42, v43
    s_waitcnt lgkmcnt(2)
    v_mfma_f32_32x32x16_bf16 v[64:79], v[116:119], v[96:99], v[64:79]
    s_mov_b64 exec, s[34:35]
    ds_read_b128 v[124:127], v9 offset:12800
    ds_read_b128 v[128:131], v9 offset:13440
    s_mov_b64 exec, -1
    v_exp_f32 v44, v44
    v_exp_f32 v45, v45
    v_exp_f32 v46, v46
    v_exp_f32 v47, v47
    v_cvt_pk_bf16_f32 v102, v44, v45
    v_cvt_pk_bf16_f32 v103, v46, v47
    v_exp_f32 v48, v48
    v_exp_f32 v49, v49
    v_mfma_f32_32x32x16_bf16 v[64:79], v[120:123], v[100:103], v[64:79]
    v_exp_f32 v50, v50
    v_exp_f32 v51, v51
    v_cvt_pk_bf16_f32 v96, v48, v49
    v_cvt_pk_bf16_f32 v97, v50, v51
    s_waitcnt lgkmcnt(2)
    v_mfma_f32_32x32x16_bf16 v[32:47], v[108:111], v[20:23], 0
    v_exp_f32 v52, v52
    v_exp_f32 v53, v53
    v_exp_f32 v54, v54
    v_exp_f32 v55, v55
    v_cvt_pk_bf16_f32 v98, v52, v53
    v_cvt_pk_bf16_f32 v99, v54, v55
    v_mfma_f32_32x32x8_bf16 v[32:47], v[114:115], v[28:29], v[32:47]
    v_exp_f32 v56, v56
    v_exp_f32 v57, v57
    v_exp_f32 v58, v58
    v_exp_f32 v59, v59
    v_cvt_pk_bf16_f32 v100, v56, v57
    v_cvt_pk_bf16_f32 v101, v58, v59
    v_mfma_f32_32x32x16_bf16 v[80:95], v[116:119], v[96:99], v[80:95]
    v_exp_f32 v60, v60
    v_exp_f32 v61, v61
    v_exp_f32 v62, v62
    v_exp_f32 v63, v63
    v_cvt_pk_bf16_f32 v102, v60, v61
    v_cvt_pk_bf16_f32 v103, v62, v63
    s_cmp_eq_u32 s23, 0
    s_cbranch_scc0 L_at_nc5
    s_barrier
L_at_nc5:
    v_exp_f32 v32, v32
    v_exp_f32 v33, v33
    v_mfma_f32_32x32x16_bf16 v[80:95], v[120:123], v[100:103], v[80:95]
    v_exp_f32 v34, v34
    v_exp_f32 v35, v35
    v_cvt_pk_bf16_f32 v96, v32, v33
    v_cvt_pk_bf16_f32 v97, v34, v35
    v_mfma_f32_32x32x16_bf16 v[48:63], v[108:111], v[24:27], 0
    ds_read2st64_b64 v[104:107], v7 offset0:30 offset1:31
    ds_read_b64 v[112:113], v8 offset:15360
    v_exp_f32 v36, v36
    v_exp_f32 v37, v37
    v_exp_f32 v38, v38
    v_exp_f32 v39, v39
    v_cvt_pk_bf16_f32 v98, v36, v37
    v_cvt_pk_bf16_f32 v99, v38, v39
    v_mfma_f32_32x32x8_bf16 v[48:63], v[114:115], v[30:31], v[48:63]
    v_exp_f32 v40, v40
    v_exp_f32 v41, v41
    v_exp_f32 v42, v42
    v_exp_f32 v43, v43
    v_cvt_pk_bf16_f32 v100, v40, v41
    v_cvt_pk_bf16_f32 v101, v42, v43
    s_waitcnt lgkmcnt(2)
    v_mfma_f32_32x32x16_bf16 v[64:79], v[124:127], v[96:99], v[64:79]
    s_mov_b64 exec, s[34:35]
    ds_read_b128 v[116:119], v9 offset:15360
    ds_read_b128 v[120:123], v9 offset:16000
    s_mov_b64 exec, -1
    v_exp_f32 v44, v44
    v_exp_f32 v45, v45
    v_exp_f32 v46, v46
    v_exp_f32 v47, v47
    v_cvt_pk_bf16_f32 v102, v44, v45
    v_cvt_pk_bf16_f32 v103, v46, v47
    v_exp_f32 v48, v48
    v_exp_f32 v49, v49
    v_mfma_f32_32x32x16_bf16 v[64:79], v[128:131], v[100:103], v[64:79]
    v_exp_f32 v50, v50
    v_exp_f32 v51, v51
    v_cvt_pk_bf16_f32 v96, v48, v49
    v_cvt_pk_bf16_f32 v97, v50, v51
    s_waitcnt lgkmcnt(2)
    v_mfma_f32_32x32x16_bf16 v[32:47], v[104:107], v[20:23], 0
    v_exp_f32 v52, v52
    v_exp_f32 v53, v53
    v_exp_f32 v54, v54
    v_exp_f32 v55, v55
    v_cvt_pk_bf16_f32 v98, v52, v53
    v_cvt_pk_bf16_f32 v99, v54, v55
    v_mfma_f32_32x32x8_bf16 v[32:47], v[112:113], v[28:29], v[32:47]
    v_exp_f32 v56, v56
    v_exp_f32 v57, v57
    v_exp_f32 v58, v58
    v_exp_f32 v59, v59
    v_cvt_pk_bf16_f32 v100, v56, v57
    v_cvt_pk_bf16_f32 v101, v58, v59
    v_mfma_f32_32x32x16_bf16 v[80:95], v[124:127], v[96:99], v[80:95]
    v_exp_f32 v60, v60
    v_exp_f32 v61, v61
    v_exp_f32 v62, v62
    v_exp_f32 v63, v63
    v_cvt_pk_bf16_f32 v102, v60, v61
    v_cvt_pk_bf16_f32 v103, v62, v63
    v_exp_f32 v32, v32
    v_exp_f32 v33, v33
    v_mfma_f32_32x32x16_bf16 v[80:95], v[128:131], v[100:103], v[80:95]
    v_exp_f32 v34, v34
    v_exp_f32 v35, v35
    v_cvt_pk_bf16_f32 v96, v32, v33
    v_cvt_pk_bf16_f32 v97, v34, v35
    v_mfma_f32_32x32x16_bf16 v[48:63], v[104:107], v[24:27], 0
    ds_read2st64_b64 v[108:111], v7 offset0:35 offset1:36
    ds_read_b64 v[114:115], v8 offset:17920
    v_exp_f32 v36, v36
    v_exp_f32 v37, v37
    v_exp_f32 v38, v38
    v_exp_f32 v39, v39
    v_cvt_pk_bf16_f32 v98, v36, v37
    v_cvt_pk_bf16_f32 v99, v38, v39
    v_mfma_f32_32x32x8_bf16 v[48:63], v[112:113], v[30:31], v[48:63]
    v_exp_f32 v40, v40
    v_exp_f32 v41, v41
    v_exp_f32 v42, v42
    v_exp_f32 v43, v43
    v_cvt_pk_bf16_f32 v100, v40, v41
    v_cvt_pk_bf16_f32 v101, v42, v43
    s_waitcnt lgkmcnt(2)
    v_mfma_f32_32x32x16_bf16 v[64:79], v[116:119], v[96:99], v[64:79]
    s_mov_b64 exec, s[34:35]
    ds_read_b128 v[124:127], v9 offset:17920
    ds_read_b128 v[128:131], v9 offset:18560
    s_mov_b64 exec, -1
    v_exp_f32 v44, v44
    v_exp_f32 v45, v45
    v_exp_f32 v46, v46
    v_exp_f32 v47, v47
    v_cvt_pk_bf16_f32 v102, v44, v45
    v_cvt_pk_bf16_f32 v103, v46, v47
    v_exp_f32 v48, v48
    v_exp_f32 v49, v49
    v_mfma_f32_32x32x16_bf16 v[64:79], v[120:123], v[100:103], v[64:79]
    v_exp_f32 v50, v50
    v_exp_f32 v51, v51
    v_cvt_pk_bf16_f32 v96, v48, v49
    v_cvt_pk_bf16_f32 v97, v50, v51
    s_waitcnt lgkmcnt(2)
    v_mfma_f32_32x32x16_bf16 v[32:47], v[108:111], v[20:23], 0
    v_exp_f32 v52, v52
    v_exp_f32 v53, v53
    v_exp_f32 v54, v54
    v_exp_f32 v55, v55
    v_cvt_pk_bf16_f32 v98, v52, v53
    v_cvt_pk_bf16_f32 v99, v54, v55
    v_mfma_f32_32x32x8_bf16 v[32:47], v[114:115], v[28:29], v[32:47]
    v_exp_f32 v56, v56
    v_exp_f32 v57, v57
    v_exp_f32 v58, v58
    v_exp_f32 v59, v59
    v_cvt_pk_bf16_f32 v100, v56, v57
    v_cvt_pk_bf16_f32 v101, v58, v59
    v_mfma_f32_32x32x16_bf16 v[80:95], v[116:119], v[96:99], v[80:95]
    v_exp_f32 v60, v60
    v_exp_f32 v61, v61
    v_exp_f32 v62, v62
    v_exp_f32 v63, v63
    v_cvt_pk_bf16_f32 v102, v60, v61
    v_cvt_pk_bf16_f32 v103, v62, v63
    v_exp_f32 v32, v32
    v_exp_f32 v33, v33
    v_mfma_f32_32x32x16_bf16 v[80:95], v[120:123], v[100:103], v[80:95]
    v_exp_f32 v34, v34
    v_exp_f32 v35, v35
    v_cvt_pk_bf16_f32 v96, v32, v33
    v_cvt_pk_bf16_f32 v97, v34, v35
    v_add_u32 v7, s38, v7
    v_add_u32 v8, s38, v8
    v_add_u32 v9, s38, v9
    v_mfma_f32_32x32x16_bf16 v[48:63], v[108:111], v[24:27], 0
    ds_read2st64_b64 v[104:107], v7 offset0:0 offset1:1
    ds_read_b64 v[112:113], v8 offset:0
    v_exp_f32 v36, v36
    v_exp_f32 v37, v37
    v_exp_f32 v38, v38
    v_exp_f32 v39, v39
    v_cvt_pk_bf16_f32 v98, v36, v37
    v_cvt_pk_bf16_f32 v99, v38, v39
    v_mfma_f32_32x32x8_bf16 v[48:63], v[114:115], v[30:31], v[48:63]
    v_exp_f32 v40, v40
    v_exp_f32 v41, v41
    v_exp_f32 v42, v42
    v_exp_f32 v43, v43
    v_cvt_pk_bf16_f32 v100, v40, v41
    v_cvt_pk_bf16_f32 v101, v42, v43
    s_waitcnt lgkmcnt(2)
    v_mfma_f32_32x32x16_bf16 v[64:79], v[124:127], v[96:99], v[64:79]
    s_mov_b64 exec, s[34:35]
    ds_read_b128 v[116:119], v9 offset:0
    ds_read_b128 v[120:123], v9 offset:640
    s_mov_b64 exec, -1
    v_exp_f32 v44, v44
    v_exp_f32 v45, v45
    v_exp_f32 v46, v46
    v_exp_f32 v47, v47
    v_cvt_pk_bf16_f32 v102, v44, v45
    v_cvt_pk_bf16_f32 v103, v46, v47
    v_exp_f32 v48, v48
    v_exp_f32 v49, v49
    v_mfma_f32_32x32x16_bf16 v[64:79], v[128:131], v[100:103], v[64:79]
    v_exp_f32 v50, v50
    v_exp_f32 v51, v51
    v_cvt_pk_bf16_f32 v96, v48, v49
    v_cvt_pk_bf16_f32 v97, v50, v51
    s_waitcnt lgkmcnt(2)
    v_mfma_f32_32x32x16_bf16 v[32:47], v[104:107], v[20:23], 0
    v_exp_f32 v52, v52
    v_exp_f32 v53, v53
    v_exp_f32 v54, v54
    v_exp_f32 v55, v55
    v_cvt_pk_bf16_f32 v98, v52, v53
    v_cvt_pk_bf16_f32 v99, v54, v55
    v_mfma_f32_32x32x8_bf16 v[32:47], v[112:113], v[28:29], v[32:47]
    v_exp_f32 v56, v56
    v_exp_f32 v57, v57
    v_exp_f32 v58, v58
    v_exp_f32 v59, v59
    v_cvt_pk_bf16_f32 v100, v56, v57
    v_cvt_pk_bf16_f32 v101, v58, v59
    v_mfma_f32_32x32x16_bf16 v[80:95], v[124:127], v[96:99], v[80:95]
    v_exp_f32 v60, v60
    v_exp_f32 v61, v61
    v_exp_f32 v62, v62
    v_exp_f32 v63, v63
    v_cvt_pk_bf16_f32 v102, v60, v61
    v_cvt_pk_bf16_f32 v103, v62, v63
    s_add_u32 s23, s23, 1
    s_cmp_eq_u32 s23, 1
    s_cbranch_scc0 L_at_n1
    s_setprio 2
    s_branch L_at_loop
L_at_n1:
    s_cmp_eq_u32 s23, 2
    s_cbranch_scc0 L_at_n2
    s_setprio 1
    s_branch L_at_loop
L_at_n2:
    s_setprio 0
    s_cmp_lt_u32 s23, 4
    s_cbranch_scc1 L_at_loop
    s_setprio 2
    v_mfma_f32_32x32x16_bf16 v[80:95], v[128:131], v[100:103], v[80:95]
    s_cmp_eq_u32 s37, 0
    s_waitcnt lgkmcnt(0)
    s_cbranch_scc1 L_at_lo
    ds_write_b128 v13, v[64:67] offset:0
    ds_write_b128 v13, v[68:71] offset:1024
    ds_write_b128 v13, v[72:75] offset:2048
    v_mov_b32 v20, v24
    v_mov_b32 v21, v25
    v_mov_b32 v22, v26
    v_mov_b32 v23, v27
    v_mov_b32 v28, v30
    v_mov_b32 v29, v31
    s_waitcnt lgkmcnt(0)
    s_barrier
    ds_read_b128 v[72:75], v14 offset:2048
    ds_read_b128 v[64:67], v14 offset:0
    ds_read_b128 v[68:71], v14 offset:1024
    s_branch L_at_sum
L_at_lo:
    s_nop 7
    s_nop 0
    ds_write_b128 v13, v[80:83] offset:0
    ds_write_b128 v13, v[84:87] offset:1024
    ds_write_b128 v13, v[88:91] offset:2048
    s_waitcnt lgkmcnt(0)
    s_barrier
    ds_read_b128 v[88:91], v14 offset:2048
    ds_read_b128 v[80:83], v14 offset:0
    ds_read_b128 v[84:87], v14 offset:1024
L_at_sum:
    s_waitcnt lgkmcnt(2)
    v_pk_add_f32 v[72:73], v[72:73], v[88:89]
    v_mov_b32 v1, v72
    v_mov_b32 v2, v72
    v_pk_add_f32 v[74:75], v[74:75], v[90:91]
    s_waitcnt lgkmcnt(0)
    v_permlane32_swap_b32 v1, v2
    v_pk_add_f32 v[64:65], v[64:65], v[80:81]
    v_pk_add_f32 v[66:67], v[66:67], v[82:83]
    v_pk_add_f32 v[68:69], v[68:69], v[84:85]
    v_pk_add_f32 v[70:71], v[70:71], v[86:87]
    v_cmp_le_f32 vcc, s31, v2
    v_cmp_ge_f32 s[40:41], s43, v2
    v_rcp_f32 v16, v2
    s_nop 1
    s_and_b64 vcc, vcc, s[40:41]
    s_cmp_eq_u64 vcc, -1
    s_cbranch_scc0 L_at_slow
L_at_store:
    v_pk_mul_f32 v[64:65], v[64:65], v[16:17] op_sel_hi:[1,0]
    v_pk_mul_f32 v[66:67], v[66:67], v[16:17] op_sel_hi:[1,0]
    v_pk_mul_f32 v[68:69], v[68:69], v[16:17] op_sel_hi:[1,0]
    v_pk_mul_f32 v[70:71], v[70:71], v[16:17] op_sel_hi:[1,0]
    v_pk_mul_f32 v[72:73], v[72:73], v[16:17] op_sel_hi:[1,0]
    v_pk_mul_f32 v[74:75], v[74:75], v[16:17] op_sel_hi:[1,0]
    v_cvt_pk_bf16_f32 v96, v64, v65
    v_cvt_pk_bf16_f32 v97, v66, v67
    v_cvt_pk_bf16_f32 v98, v68, v69
    v_cvt_pk_bf16_f32 v99, v70, v71
    v_cvt_pk_bf16_f32 v100, v72, v73
    v_cvt_pk_bf16_f32 v101, v74, v75
    s_nop 0
    v_permlane32_swap_b32 v96, v98
    v_permlane32_swap_b32 v97, v99
    buffer_store_dwordx4 v[96:99], v11, s[4:7], s33 offen sc1
    s_mov_b32 exec_hi, 0
    buffer_store_dwordx2 v[100:101], v12, s[4:7], s39 offen sc1
    s_mov_b32 exec_hi, -1
    s_lshl_b32 s60, s42, 7
    v_mul_u32_u24 v1, 139264, v0
    v_add_u32 v1, s60, v1
    v_mov_b32 v2, 1
    s_waitcnt vmcnt(0)
    s_mov_b64 exec, 1
    buffer_atomic_add v2, v1, s[4:7], 0 offen sc1
    s_mov_b64 exec, -1
    s_branch L_g2
L_at_slow:
    v_and_b32 v1, 31, v0
    v_lshlrev_b32 v8, 3, v1
    v_lshlrev_b32 v7, 3, v0
    v_add_u32 v8, 1024, v8
    v_lshrrev_b32 v2, 5, v0
    v_mul_u32_u24 v9, 320, v2
    v_lshl_add_u32 v9, v1, 4, v9
    v_add_u32 v9, 1280, v9
    v_mov_b32 v10, 0xff61b1e6
    s_mov_b32 s23, 0
    v_mov_b32 v64, 0
    v_mov_b32 v65, 0
    v_mov_b32 v66, 0
    v_mov_b32 v67, 0
    v_mov_b32 v68, 0
    v_mov_b32 v69, 0
    v_mov_b32 v70, 0
    v_mov_b32 v71, 0
    v_mov_b32 v72, 0
    v_mov_b32 v73, 0
    v_mov_b32 v74, 0
    v_mov_b32 v75, 0
    v_mov_b32 v76, 0
    v_mov_b32 v77, 0
    v_mov_b32 v78, 0
    v_mov_b32 v79, 0
L_at_slow_loop:
    buffer_load_dwordx2 v[104:105], v7, s[4:7], s46 offen offset:0 sc1
    buffer_load_dwordx2 v[106:107], v7, s[4:7], s46 offen offset:512 sc1
    buffer_load_dwordx2 v[112:113], v8, s[4:7], s46 offen sc1
    s_mov_b64 exec, s[34:35]
    buffer_load_dwordx4 v[116:119], v9, s[4:7], s46 offen sc1
    buffer_load_dwordx4 v[120:123], v9, s[4:7], s46 offen offset:640 sc1
    s_mov_b64 exec, -1
    s_waitcnt vmcnt(0)
    v_mfma_f32_32x32x16_bf16 v[32:47], v[104:107], v[20:23], 0
    v_mfma_f32_32x32x8_bf16 v[32:47], v[112:113], v[28:29], v[32:47]
    s_nop 7
    s_nop 7
    v_max3_f32 v1, v32, v33, v10
    v_max3_f32 v1, v34, v35, v1
    v_max3_f32 v1, v36, v37, v1
    v_max3_f32 v1, v38, v39, v1
    v_max3_f32 v1, v40, v41, v1
    v_max3_f32 v1, v42, v43, v1
    v_max3_f32 v1, v44, v45, v1
    v_max3_f32 v1, v46, v47, v1
    v_mov_b32 v2, v1
    s_nop 1
    v_permlane32_swap_b32 v1, v2
    s_nop 1
    v_max_f32 v1, v1, v2
    v_sub_f32 v3, v10, v1
    v_exp_f32 v3, v3
    v_mov_b32 v10, v1
    v_sub_f32 v32, v32, v10
    v_sub_f32 v33, v33, v10
    v_sub_f32 v34, v34, v10
    v_sub_f32 v35, v35, v10
    v_sub_f32 v36, v36, v10
    v_sub_f32 v37, v37, v10
    v_sub_f32 v38, v38, v10
    v_sub_f32 v39, v39, v10
    v_sub_f32 v40, v40, v10
    v_sub_f32 v41, v41, v10
    v_sub_f32 v42, v42, v10
    v_sub_f32 v43, v43, v10
    v_sub_f32 v44, v44, v10
    v_sub_f32 v45, v45, v10
    v_sub_f32 v46, v46, v10
    v_sub_f32 v47, v47, v10
    v_exp_f32 v32, v32
    v_exp_f32 v33, v33
    v_exp_f32 v34, v34
    v_exp_f32 v35, v35
    v_exp_f32 v36, v36
    v_exp_f32 v37, v37
    v_exp_f32 v38, v38
    v_exp_f32 v39, v39
    v_exp_f32 v40, v40
    v_exp_f32 v41, v41
    v_exp_f32 v42, v42
    v_exp_f32 v43, v43
    v_exp_f32 v44, v44
    v_exp_f32 v45, v45
    v_exp_f32 v46, v46
    v_exp_f32 v47, v47
    v_mul_f32 v64, v64, v3
    v_mul_f32 v65, v65, v3
    v_mul_f32 v66, v66, v3
    v_mul_f32 v67, v67, v3
    v_mul_f32 v68, v68, v3
    v_mul_f32 v69, v69, v3
    v_mul_f32 v70, v70, v3
    v_mul_f32 v71, v71, v3
    v_mul_f32 v72, v72, v3
    v_mul_f32 v73, v73, v3
    v_mul_f32 v74, v74, v3
    v_mul_f32 v75, v75, v3
    v_mul_f32 v76, v76, v3
    v_mul_f32 v77, v77, v3
    v_mul_f32 v78, v78, v3
    v_mul_f32 v79, v79, v3
    v_cvt_pk_bf16_f32 v96, v32, v33
    v_cvt_pk_bf16_f32 v97, v34, v35
    v_cvt_pk_bf16_f32 v98, v36, v37
    v_cvt_pk_bf16_f32 v99, v38, v39
    v_cvt_pk_bf16_f32 v100, v40, v41
    v_cvt_pk_bf16_f32 v101, v42, v43
    v_cvt_pk_bf16_f32 v102, v44, v45
    v_cvt_pk_bf16_f32 v103, v46, v47
    s_nop 1
    v_mfma_f32_32x32x16_bf16 v[64:79], v[116:119], v[96:99], v[64:79]
    v_mfma_f32_32x32x16_bf16 v[64:79], v[120:123], v[100:103], v[64:79]
    s_add_u32 s46, s46, 2560
    s_nop 7
    s_nop 7
    s_add_u32 s23, s23, 1
    s_cmp_lt_u32 s23, 64
    s_cbranch_scc1 L_at_slow_loop
    v_mov_b32 v1, v72
    v_mov_b32 v2, v72
    s_nop 1
    v_permlane32_swap_b32 v1, v2
    v_rcp_f32 v16, v2
    s_nop 0
    s_branch L_at_store
L_g1a:
    s_cmp_lt_u32 s3, 4
    s_cbranch_scc1 L_g1a_comp
    s_cmp_ge_u32 s3, 8
    s_cbranch_scc1 L_g1a_h
    s_barrier
    s_barrier
    s_branch L_at
L_g1a_h:
    s_waitcnt vmcnt(0)
    s_barrier
    s_barrier
    s_branch L_at
L_g1a_comp:
    s_bfe_u32 s20, s2, 0x20001
    s_lshl_b32 s20, s20, 2
    s_bfe_u32 s28, s2, 0x20003
    s_add_u32 s20, s20, s28
    s_and_b32 s21, s2, 1
    s_lshl_b32 s21, s21, 3
    s_lshr_b32 s28, s2, 5
    s_add_u32 s21, s21, s28
    v_and_b32 v1, 15, v0
    v_lshrrev_b32 v2, 4, v0
    s_sub_u32 s40, s92, 1
    s_lshl_b32 s33, s40, 17
    s_add_u32 s33, s33, 139264
    s_mul_i32 s41, s40, 2621440
    s_add_u32 s41, s41, 33955840
    s_lshr_b32 s28, s21, 2
    s_mul_i32 s29, s28, 40960
    s_and_b32 s28, s21, 3
    s_mul_i32 s28, s28, 5120
    s_add_u32 s29, s29, s28
    s_add_u32 s29, s29, 532480
    v_lshlrev_b32 v11, 3, v1
    v_lshl_add_u32 v11, v2, 8, v11
    v_lshlrev_b32 v3, 4, v0
    v_add_u32 v4, 20480, v3
    s_lshl_b32 s36, s20, 3
    s_lshl_b32 s28, s3, 1
    s_add_u32 s36, s36, s28
    s_mul_i32 s38, s36, 20480
    s_add_u32 s38, s38, s41
    v_add_u32 v5, 0, v3
    s_lshl_b32 s28, s40, 7
    s_add_u32 s28, s28, s36
    s_add_u32 s28, s28, 576
    v_add_u32 v16, s28, v0
    s_lshl_b32 s28, s36, 10
    s_add_u32 s33, s33, s28
    v_cmp_gt_u32 vcc, 2, v2
    v_mov_b32 v14, 0x3ea52b5c
    s_lshl_b32 s28, s20, 2
    s_add_u32 s28, s28, s3
    s_mul_i32 s31, s28, 1280
    s_mul_i32 s30, s21, 163840
    s_add_u32 s28, s31, s30
    s_add_u32 s28, s28, 15605760
    s_add_u32 s30, s30, s31
    s_add_u32 s30, s30, 2293760
    s_mov_b32 s31, 163840
    v_mul_u32_u24 v12, 81920, v2
    v_mov_b32 v13, s30
    v_mad_u32_u24 v13, v2, s31, v13
    v_cndmask_b32 v12, v13, v12, vcc
    v_cndmask_b32 v14, 1.0, v14, vcc
    v_add_u32 v12, s28, v12
    v_lshl_add_u32 v6, v1, 4, v12
    v_lshlrev_b32 v7, 4, v2
    s_add_u32 s28, s28, s30
    s_add_u32 s28, s28, 328960
    v_mul_u32_u24 v12, 320, v2
    v_lshl_add_u32 v12, v1, 4, v12
    v_add_u32 v8, s28, v12
    v_cmp_gt_u32 vcc, 4, v1
    v_add_u32 v13, 256, v8
    v_add_u32 v15, 163776, v8
    v_cndmask_b32 v9, v15, v13, vcc
    v_cmp_gt_u32 vcc, 8, v1
    v_add_u32 v13, 164032, v8
    v_mov_b32 v15, 2147418112
    v_cndmask_b32 v10, v15, v13, vcc
    v_lshlrev_b32 v16, 7, v16
    s_lshl_b32 s28, s40, 7
    s_add_u32 s28, s28, s36
    s_add_u32 s28, s28, 576
    s_lshl_b32 s60, s28, 7
    s_add_u32 s58, s4, s60
    s_addc_u32 s59, s5, 0
    s_mov_b32 s61, 0
L_g1a_poll:
    s_mov_b32 s16, 0
    s_mov_b32 s17, 0
    s_atomic_add s16, s[58:59], 0 glc
    s_atomic_add s17, s[58:59], 128 glc
    s_add_u32 s61, s61, 1
    s_waitcnt lgkmcnt(0)
    s_min_u32 s16, s16, s17
    s_cmp_ge_u32 s16, 8
    s_cbranch_scc1 L_g1a_poll_ok
    s_cmp_lt_u32 s61, 200000
    s_cbranch_scc1 L_g1a_poll
L_g1a_poll_ok:
    buffer_load_dwordx2 v[18:19], v11, s[4:7], s33 offen offset:0 sc1
    buffer_load_dwordx2 v[20:21], v11, s[4:7], s33 offen offset:128 sc1
    buffer_load_dwordx2 v[22:23], v11, s[4:7], s33 offen offset:1024 sc1
    buffer_load_dwordx2 v[24:25], v11, s[4:7], s33 offen offset:1152 sc1
    buffer_load_dwordx4 v[124:127], v3, s[4:7], s38 offen offset:0 sc1
    buffer_load_dwordx4 v[128:131], v4, s[4:7], s38 offen offset:0 sc1
    buffer_load_dwordx4 v[132:135], v3, s[4:7], s38 offen offset:1024 sc1
    buffer_load_dwordx4 v[136:139], v4, s[4:7], s38 offen offset:1024 sc1
    buffer_load_dwordx4 v[140:143], v3, s[4:7], s38 offen offset:2048 sc1
    buffer_load_dwordx4 v[144:147], v4, s[4:7], s38 offen offset:2048 sc1
    buffer_load_dwordx4 v[148:151], v3, s[4:7], s38 offen offset:3072 sc1
    buffer_load_dwordx4 v[152:155], v4, s[4:7], s38 offen offset:3072 sc1
    s_add_u32 s38, s38, 4096
    s_add_u32 s39, s38, 1024
    s_mov_b32 s23, 0
    s_mov_b32 s47, 40960
    ds_read_b128 v[92:95], v5 offset:0
    ds_read_b128 v[96:99], v5 offset:1024
    ds_read_b128 v[100:103], v5 offset:2048
    ds_read_b128 v[104:107], v5 offset:3072
    ds_read_b128 v[108:111], v5 offset:4096
    ds_read_b128 v[112:115], v5 offset:5120
    ds_read_b128 v[116:119], v5 offset:6144
    s_waitcnt vmcnt(6)
    s_waitcnt lgkmcnt(6)
    v_mfma_f32_16x16x32_bf16 v[28:31], v[92:95], v[124:127], 0
    ds_read_b128 v[120:123], v5 offset:7168
    v_mfma_f32_16x16x32_bf16 v[60:63], v[92:95], v[128:131], 0
    v_pk_add_f32 v[18:19], v[18:19], v[20:21]
    v_pk_add_f32 v[22:23], v[22:23], v[24:25]
    s_waitcnt lgkmcnt(6)
    v_mfma_f32_16x16x32_bf16 v[32:35], v[96:99], v[124:127], 0
    ds_read_b128 v[92:95], v5 offset:8192
    v_mfma_f32_16x16x32_bf16 v[64:67], v[96:99], v[128:131], 0
    buffer_load_dwordx4 v[156:159], v3, s[4:7], s38 offen offset:0 sc1
    s_waitcnt lgkmcnt(6)
    v_mfma_f32_16x16x32_bf16 v[36:39], v[100:103], v[124:127], 0
    ds_read_b128 v[96:99], v5 offset:9216
    v_mfma_f32_16x16x32_bf16 v[68:71], v[100:103], v[128:131], 0
    v_mov_b32 v20, v18
    v_mov_b32 v21, v19
    s_waitcnt lgkmcnt(6)
    v_mfma_f32_16x16x32_bf16 v[40:43], v[104:107], v[124:127], 0
    ds_read_b128 v[100:103], v5 offset:10240
    v_mfma_f32_16x16x32_bf16 v[72:75], v[104:107], v[128:131], 0
    v_mov_b32 v24, v22
    v_mov_b32 v25, v23
    s_waitcnt lgkmcnt(6)
    v_mfma_f32_16x16x32_bf16 v[44:47], v[108:111], v[124:127], 0
    ds_read_b128 v[104:107], v5 offset:11264
    v_mfma_f32_16x16x32_bf16 v[76:79], v[108:111], v[128:131], 0
    v_permlane32_swap_b32 v18, v20
    v_permlane32_swap_b32 v19, v21
    s_waitcnt lgkmcnt(6)
    v_mfma_f32_16x16x32_bf16 v[48:51], v[124:127], v[112:115], 0
    ds_read_b128 v[108:111], v5 offset:12288
    v_mfma_f32_16x16x32_bf16 v[80:83], v[128:131], v[112:115], 0
    buffer_load_dwordx4 v[160:163], v4, s[4:7], s38 offen offset:0 sc1
    s_waitcnt lgkmcnt(6)
    v_mfma_f32_16x16x32_bf16 v[52:55], v[124:127], v[116:119], 0
    ds_read_b128 v[112:115], v5 offset:13312
    v_mfma_f32_16x16x32_bf16 v[84:87], v[128:131], v[116:119], 0
    v_permlane32_swap_b32 v22, v24
    v_permlane32_swap_b32 v23, v25
    s_waitcnt lgkmcnt(6)
    v_mfma_f32_16x16x32_bf16 v[56:59], v[124:127], v[120:123], 0
    ds_read_b128 v[116:119], v5 offset:14336
    v_mfma_f32_16x16x32_bf16 v[88:91], v[128:131], v[120:123], 0
    v_add_f32 v18, v18, v20
    v_add_f32 v19, v19, v21
    s_waitcnt vmcnt(6)
    s_waitcnt lgkmcnt(6)
    v_mfma_f32_16x16x32_bf16 v[28:31], v[92:95], v[132:135], v[28:31]
    ds_read_b128 v[120:123], v5 offset:15360
    v_mfma_f32_16x16x32_bf16 v[60:63], v[92:95], v[136:139], v[60:63]
    v_add_f32 v22, v22, v24
    v_add_f32 v23, v23, v25
    s_waitcnt lgkmcnt(6)
    v_mfma_f32_16x16x32_bf16 v[32:35], v[96:99], v[132:135], v[32:35]
    ds_read_b128 v[92:95], v5 offset:16384
    v_mfma_f32_16x16x32_bf16 v[64:67], v[96:99], v[136:139], v[64:67]
    buffer_load_dwordx4 v[124:127], v3, s[4:7], s39 offen offset:0 sc1
    s_waitcnt lgkmcnt(6)
    v_mfma_f32_16x16x32_bf16 v[36:39], v[100:103], v[132:135], v[36:39]
    ds_read_b128 v[96:99], v5 offset:17408
    v_mfma_f32_16x16x32_bf16 v[68:71], v[100:103], v[136:139], v[68:71]
    v_mov_b32 v20, v18
    v_mov_b32 v21, v19
    s_waitcnt lgkmcnt(6)
    v_mfma_f32_16x16x32_bf16 v[40:43], v[104:107], v[132:135], v[40:43]
    ds_read_b128 v[100:103], v5 offset:18432
    v_mfma_f32_16x16x32_bf16 v[72:75], v[104:107], v[136:139], v[72:75]
    v_mov_b32 v24, v22
    v_mov_b32 v25, v23
    s_waitcnt lgkmcnt(6)
    v_mfma_f32_16x16x32_bf16 v[44:47], v[108:111], v[132:135], v[44:47]
    ds_read_b128 v[104:107], v5 offset:19456
    v_mfma_f32_16x16x32_bf16 v[76:79], v[108:111], v[136:139], v[76:79]
    v_permlane16_swap_b32 v18, v20
    v_permlane16_swap_b32 v19, v21
    s_waitcnt lgkmcnt(6)
    v_mfma_f32_16x16x32_bf16 v[48:51], v[132:135], v[112:115], v[48:51]
    ds_read_b128 v[108:111], v5 offset:20480
    v_mfma_f32_16x16x32_bf16 v[80:83], v[136:139], v[112:115], v[80:83]
    buffer_load_dwordx4 v[128:131], v4, s[4:7], s39 offen offset:0 sc1
    s_waitcnt lgkmcnt(6)
    v_mfma_f32_16x16x32_bf16 v[52:55], v[132:135], v[116:119], v[52:55]
    ds_read_b128 v[112:115], v5 offset:21504
    v_mfma_f32_16x16x32_bf16 v[84:87], v[136:139], v[116:119], v[84:87]
    v_permlane16_swap_b32 v22, v24
    v_permlane16_swap_b32 v23, v25
    s_waitcnt lgkmcnt(6)
    v_mfma_f32_16x16x32_bf16 v[56:59], v[132:135], v[120:123], v[56:59]
    ds_read_b128 v[116:119], v5 offset:22528
    v_mfma_f32_16x16x32_bf16 v[88:91], v[136:139], v[120:123], v[88:91]
    v_add_f32 v18, v18, v20
    v_add_f32 v19, v19, v21
    s_waitcnt vmcnt(6)
    s_waitcnt lgkmcnt(6)
    v_mfma_f32_16x16x32_bf16 v[28:31], v[92:95], v[140:143], v[28:31]
    ds_read_b128 v[120:123], v5 offset:23552
    v_mfma_f32_16x16x32_bf16 v[60:63], v[92:95], v[144:147], v[60:63]
    v_add_f32 v22, v22, v24
    v_add_f32 v23, v23, v25
    s_waitcnt lgkmcnt(6)
    v_mfma_f32_16x16x32_bf16 v[32:35], v[96:99], v[140:143], v[32:35]
    ds_read_b128 v[92:95], v5 offset:24576
    v_mfma_f32_16x16x32_bf16 v[64:67], v[96:99], v[144:147], v[64:67]
    buffer_load_dwordx4 v[132:135], v3, s[4:7], s39 offen offset:1024 sc1
    s_waitcnt lgkmcnt(6)
    v_mfma_f32_16x16x32_bf16 v[36:39], v[100:103], v[140:143], v[36:39]
    ds_read_b128 v[96:99], v5 offset:25600
    v_mfma_f32_16x16x32_bf16 v[68:71], v[100:103], v[144:147], v[68:71]
    v_mul_f32 v18, 0x3acccccd, v18
    v_mul_f32 v19, 0x3acccccd, v19
    s_waitcnt lgkmcnt(6)
    v_mfma_f32_16x16x32_bf16 v[40:43], v[104:107], v[140:143], v[40:43]
    ds_read_b128 v[100:103], v5 offset:26624
    v_mfma_f32_16x16x32_bf16 v[72:75], v[104:107], v[144:147], v[72:75]
    v_fma_f32 v19, -v18, v18, v19
    v_max_f32 v19, 0, v19
    s_waitcnt lgkmcnt(6)
    v_mfma_f32_16x16x32_bf16 v[44:47], v[108:111], v[140:143], v[44:47]
    ds_read_b128 v[104:107], v5 offset:27648
    v_mfma_f32_16x16x32_bf16 v[76:79], v[108:111], v[144:147], v[76:79]
    v_add_f32 v19, 0x3727c5ac, v19
    v_rsq_f32 v19, v19
    s_waitcnt lgkmcnt(6)
    v_mfma_f32_16x16x32_bf16 v[48:51], v[140:143], v[112:115], v[48:51]
    ds_read_b128 v[108:111], v5 offset:28672
    v_mfma_f32_16x16x32_bf16 v[80:83], v[144:147], v[112:115], v[80:83]
    buffer_load_dwordx4 v[136:139], v4, s[4:7], s39 offen offset:1024 sc1
    s_waitcnt lgkmcnt(6)
    v_mfma_f32_16x16x32_bf16 v[52:55], v[140:143], v[116:119], v[52:55]
    ds_read_b128 v[112:115], v5 offset:29696
    v_mfma_f32_16x16x32_bf16 v[84:87], v[144:147], v[116:119], v[84:87]
    v_mul_f32 v22, 0x3acccccd, v22
    s_waitcnt lgkmcnt(6)
    v_mfma_f32_16x16x32_bf16 v[56:59], v[140:143], v[120:123], v[56:59]
    ds_read_b128 v[116:119], v5 offset:30720
    v_mfma_f32_16x16x32_bf16 v[88:91], v[144:147], v[120:123], v[88:91]
    v_mul_f32 v23, 0x3acccccd, v23
    s_waitcnt vmcnt(6)
    s_waitcnt lgkmcnt(6)
    v_mfma_f32_16x16x32_bf16 v[28:31], v[92:95], v[148:151], v[28:31]
    ds_read_b128 v[120:123], v5 offset:31744
    v_mfma_f32_16x16x32_bf16 v[60:63], v[92:95], v[152:155], v[60:63]
    v_fma_f32 v23, -v22, v22, v23
    s_waitcnt lgkmcnt(6)
    v_mfma_f32_16x16x32_bf16 v[32:35], v[96:99], v[148:151], v[32:35]
    ds_read_b128 v[92:95], v5 offset:32768
    v_mfma_f32_16x16x32_bf16 v[64:67], v[96:99], v[152:155], v[64:67]
    buffer_load_dwordx4 v[140:143], v3, s[4:7], s39 offen offset:2048 sc1
    s_waitcnt lgkmcnt(6)
    v_mfma_f32_16x16x32_bf16 v[36:39], v[100:103], v[148:151], v[36:39]
    ds_read_b128 v[96:99], v5 offset:33792
    v_mfma_f32_16x16x32_bf16 v[68:71], v[100:103], v[152:155], v[68:71]
    v_max_f32 v23, 0, v23
    s_waitcnt lgkmcnt(6)
    v_mfma_f32_16x16x32_bf16 v[40:43], v[104:107], v[148:151], v[40:43]
    ds_read_b128 v[100:103], v5 offset:34816
    v_mfma_f32_16x16x32_bf16 v[72:75], v[104:107], v[152:155], v[72:75]
    v_add_f32 v23, 0x3727c5ac, v23
    s_waitcnt lgkmcnt(6)
    v_mfma_f32_16x16x32_bf16 v[44:47], v[108:111], v[148:151], v[44:47]
    ds_read_b128 v[104:107], v5 offset:35840
    v_mfma_f32_16x16x32_bf16 v[76:79], v[108:111], v[152:155], v[76:79]
    v_rsq_f32 v23, v23
    s_waitcnt lgkmcnt(6)
    v_mfma_f32_16x16x32_bf16 v[48:51], v[148:151], v[112:115], v[48:51]
    ds_read_b128 v[108:111], v5 offset:36864
    v_mfma_f32_16x16x32_bf16 v[80:83], v[152:155], v[112:115], v[80:83]
    buffer_load_dwordx4 v[144:147], v4, s[4:7], s39 offen offset:2048 sc1
    s_waitcnt lgkmcnt(6)
    v_mfma_f32_16x16x32_bf16 v[52:55], v[148:151], v[116:119], v[52:55]
    ds_read_b128 v[112:115], v5 offset:37888
    v_mfma_f32_16x16x32_bf16 v[84:87], v[152:155], v[116:119], v[84:87]
    v_mul_f32 v20, v14, v19
    s_waitcnt lgkmcnt(6)
    v_mfma_f32_16x16x32_bf16 v[56:59], v[148:151], v[120:123], v[56:59]
    ds_read_b128 v[116:119], v5 offset:38912
    v_mfma_f32_16x16x32_bf16 v[88:91], v[152:155], v[120:123], v[88:91]
    v_mul_f32 v24, v14, v23
    s_waitcnt vmcnt(6)
    s_waitcnt lgkmcnt(6)
    v_mfma_f32_16x16x32_bf16 v[28:31], v[92:95], v[156:159], v[28:31]
    ds_read_b128 v[120:123], v5 offset:39936
    v_mfma_f32_16x16x32_bf16 v[60:63], v[92:95], v[160:163], v[60:63]
    v_add_u32 v5, s47, v5
    s_waitcnt lgkmcnt(6)
    v_mfma_f32_16x16x32_bf16 v[32:35], v[96:99], v[156:159], v[32:35]
    ds_read_b128 v[92:95], v5 offset:0
    v_mfma_f32_16x16x32_bf16 v[64:67], v[96:99], v[160:163], v[64:67]
    buffer_load_dwordx4 v[148:151], v3, s[4:7], s39 offen offset:3072 sc1
    s_waitcnt lgkmcnt(6)
    v_mfma_f32_16x16x32_bf16 v[36:39], v[100:103], v[156:159], v[36:39]
    ds_read_b128 v[96:99], v5 offset:1024
    v_mfma_f32_16x16x32_bf16 v[68:71], v[100:103], v[160:163], v[68:71]
    s_add_u32 s38, s38, 5120
    s_waitcnt lgkmcnt(6)
    v_mfma_f32_16x16x32_bf16 v[40:43], v[104:107], v[156:159], v[40:43]
    ds_read_b128 v[100:103], v5 offset:2048
    v_mfma_f32_16x16x32_bf16 v[72:75], v[104:107], v[160:163], v[72:75]
    s_add_u32 s23, s23, 1
    s_waitcnt lgkmcnt(6)
    v_mfma_f32_16x16x32_bf16 v[44:47], v[108:111], v[156:159], v[44:47]
    ds_read_b128 v[104:107], v5 offset:3072
    v_mfma_f32_16x16x32_bf16 v[76:79], v[108:111], v[160:163], v[76:79]
    s_waitcnt lgkmcnt(6)
    v_mfma_f32_16x16x32_bf16 v[48:51], v[156:159], v[112:115], v[48:51]
    ds_read_b128 v[108:111], v5 offset:4096
    v_mfma_f32_16x16x32_bf16 v[80:83], v[160:163], v[112:115], v[80:83]
    buffer_load_dwordx4 v[152:155], v4, s[4:7], s39 offen offset:3072 sc1
    s_waitcnt lgkmcnt(6)
    v_mfma_f32_16x16x32_bf16 v[52:55], v[156:159], v[116:119], v[52:55]
    ds_read_b128 v[112:115], v5 offset:5120
    v_mfma_f32_16x16x32_bf16 v[84:87], v[160:163], v[116:119], v[84:87]
    s_add_u32 s39, s38, 1024
    s_cmp_eq_u32 s23, 3
    s_cselect_b32 s39, s29, s39
    s_waitcnt lgkmcnt(6)
    v_mfma_f32_16x16x32_bf16 v[56:59], v[156:159], v[120:123], v[56:59]
    ds_read_b128 v[116:119], v5 offset:6144
    v_mfma_f32_16x16x32_bf16 v[88:91], v[160:163], v[120:123], v[88:91]
    s_cmp_lt_u32 s23, 4
    s_barrier
.p2align 4
L_g1a_loop:
    s_waitcnt vmcnt(6)
    s_waitcnt lgkmcnt(6)
    v_mfma_f32_16x16x32_bf16 v[28:31], v[92:95], v[124:127], v[28:31]
    ds_read_b128 v[120:123], v5 offset:7168
    v_mfma_f32_16x16x32_bf16 v[60:63], v[92:95], v[128:131], v[60:63]
    s_waitcnt lgkmcnt(6)
    v_mfma_f32_16x16x32_bf16 v[32:35], v[96:99], v[124:127], v[32:35]
    ds_read_b128 v[92:95], v5 offset:8192
    v_mfma_f32_16x16x32_bf16 v[64:67], v[96:99], v[128:131], v[64:67]
    buffer_load_dwordx4 v[156:159], v3, s[4:7], s38 offen offset:0 sc1
    s_waitcnt lgkmcnt(6)
    v_mfma_f32_16x16x32_bf16 v[36:39], v[100:103], v[124:127], v[36:39]
    ds_read_b128 v[96:99], v5 offset:9216
    v_mfma_f32_16x16x32_bf16 v[68:71], v[100:103], v[128:131], v[68:71]
    s_waitcnt lgkmcnt(6)
    v_mfma_f32_16x16x32_bf16 v[40:43], v[104:107], v[124:127], v[40:43]
    ds_read_b128 v[100:103], v5 offset:10240
    v_mfma_f32_16x16x32_bf16 v[72:75], v[104:107], v[128:131], v[72:75]
    s_waitcnt lgkmcnt(6)
    v_mfma_f32_16x16x32_bf16 v[44:47], v[108:111], v[124:127], v[44:47]
    ds_read_b128 v[104:107], v5 offset:11264
    v_mfma_f32_16x16x32_bf16 v[76:79], v[108:111], v[128:131], v[76:79]
    s_waitcnt lgkmcnt(6)
    v_mfma_f32_16x16x32_bf16 v[48:51], v[124:127], v[112:115], v[48:51]
    ds_read_b128 v[108:111], v5 offset:12288
    v_mfma_f32_16x16x32_bf16 v[80:83], v[128:131], v[112:115], v[80:83]
    buffer_load_dwordx4 v[160:163], v4, s[4:7], s38 offen offset:0 sc1
    s_waitcnt lgkmcnt(6)
    v_mfma_f32_16x16x32_bf16 v[52:55], v[124:127], v[116:119], v[52:55]
    ds_read_b128 v[112:115], v5 offset:13312
    v_mfma_f32_16x16x32_bf16 v[84:87], v[128:131], v[116:119], v[84:87]
    s_waitcnt lgkmcnt(6)
    v_mfma_f32_16x16x32_bf16 v[56:59], v[124:127], v[120:123], v[56:59]
    ds_read_b128 v[116:119], v5 offset:14336
    v_mfma_f32_16x16x32_bf16 v[88:91], v[128:131], v[120:123], v[88:91]
    s_waitcnt vmcnt(6)
    s_waitcnt lgkmcnt(6)
    v_mfma_f32_16x16x32_bf16 v[28:31], v[92:95], v[132:135], v[28:31]
    ds_read_b128 v[120:123], v5 offset:15360
    v_mfma_f32_16x16x32_bf16 v[60:63], v[92:95], v[136:139], v[60:63]
    s_waitcnt lgkmcnt(6)
    v_mfma_f32_16x16x32_bf16 v[32:35], v[96:99], v[132:135], v[32:35]
    ds_read_b128 v[92:95], v5 offset:16384
    v_mfma_f32_16x16x32_bf16 v[64:67], v[96:99], v[136:139], v[64:67]
    buffer_load_dwordx4 v[124:127], v3, s[4:7], s39 offen offset:0 sc1
    s_waitcnt lgkmcnt(6)
    v_mfma_f32_16x16x32_bf16 v[36:39], v[100:103], v[132:135], v[36:39]
    ds_read_b128 v[96:99], v5 offset:17408
    v_mfma_f32_16x16x32_bf16 v[68:71], v[100:103], v[136:139], v[68:71]
    s_waitcnt lgkmcnt(6)
    v_mfma_f32_16x16x32_bf16 v[40:43], v[104:107], v[132:135], v[40:43]
    ds_read_b128 v[100:103], v5 offset:18432
    v_mfma_f32_16x16x32_bf16 v[72:75], v[104:107], v[136:139], v[72:75]
    s_waitcnt lgkmcnt(6)
    v_mfma_f32_16x16x32_bf16 v[44:47], v[108:111], v[132:135], v[44:47]
    ds_read_b128 v[104:107], v5 offset:19456
    v_mfma_f32_16x16x32_bf16 v[76:79], v[108:111], v[136:139], v[76:79]
    s_waitcnt lgkmcnt(6)
    v_mfma_f32_16x16x32_bf16 v[48:51], v[132:135], v[112:115], v[48:51]
    ds_read_b128 v[108:111], v5 offset:20480
    v_mfma_f32_16x16x32_bf16 v[80:83], v[136:139], v[112:115], v[80:83]
    buffer_load_dwordx4 v[128:131], v4, s[4:7], s39 offen offset:0 sc1
    s_waitcnt lgkmcnt(6)
    v_mfma_f32_16x16x32_bf16 v[52:55], v[132:135], v[116:119], v[52:55]
    ds_read_b128 v[112:115], v5 offset:21504
    v_mfma_f32_16x16x32_bf16 v[84:87], v[136:139], v[116:119], v[84:87]
    s_waitcnt lgkmcnt(6)
    v_mfma_f32_16x16x32_bf16 v[56:59], v[132:135], v[120:123], v[56:59]
    ds_read_b128 v[116:119], v5 offset:22528
    v_mfma_f32_16x16x32_bf16 v[88:91], v[136:139], v[120:123], v[88:91]
    s_waitcnt vmcnt(6)
    s_waitcnt lgkmcnt(6)
    v_mfma_f32_16x16x32_bf16 v[28:31], v[92:95], v[140:143], v[28:31]
    ds_read_b128 v[120:123], v5 offset:23552
    v_mfma_f32_16x16x32_bf16 v[60:63], v[92:95], v[144:147], v[60:63]
    s_waitcnt lgkmcnt(6)
    v_mfma_f32_16x16x32_bf16 v[32:35], v[96:99], v[140:143], v[32:35]
    ds_read_b128 v[92:95], v5 offset:24576
    v_mfma_f32_16x16x32_bf16 v[64:67], v[96:99], v[144:147], v[64:67]
    buffer_load_dwordx4 v[132:135], v3, s[4:7], s39 offen offset:1024 sc1
    s_waitcnt lgkmcnt(6)
    v_mfma_f32_16x16x32_bf16 v[36:39], v[100:103], v[140:143], v[36:39]
    ds_read_b128 v[96:99], v5 offset:25600
    v_mfma_f32_16x16x32_bf16 v[68:71], v[100:103], v[144:147], v[68:71]
    s_waitcnt lgkmcnt(6)
    v_mfma_f32_16x16x32_bf16 v[40:43], v[104:107], v[140:143], v[40:43]
    ds_read_b128 v[100:103], v5 offset:26624
    v_mfma_f32_16x16x32_bf16 v[72:75], v[104:107], v[144:147], v[72:75]
    s_waitcnt lgkmcnt(6)
    v_mfma_f32_16x16x32_bf16 v[44:47], v[108:111], v[140:143], v[44:47]
    ds_read_b128 v[104:107], v5 offset:27648
    v_mfma_f32_16x16x32_bf16 v[76:79], v[108:111], v[144:147], v[76:79]
    s_waitcnt lgkmcnt(6)
    v_mfma_f32_16x16x32_bf16 v[48:51], v[140:143], v[112:115], v[48:51]
    ds_read_b128 v[108:111], v5 offset:28672
    v_mfma_f32_16x16x32_bf16 v[80:83], v[144:147], v[112:115], v[80:83]
    buffer_load_dwordx4 v[136:139], v4, s[4:7], s39 offen offset:1024 sc1
    s_waitcnt lgkmcnt(6)
    v_mfma_f32_16x16x32_bf16 v[52:55], v[140:143], v[116:119], v[52:55]
    ds_read_b128 v[112:115], v5 offset:29696
    v_mfma_f32_16x16x32_bf16 v[84:87], v[144:147], v[116:119], v[84:87]
    s_waitcnt lgkmcnt(6)
    v_mfma_f32_16x16x32_bf16 v[56:59], v[140:143], v[120:123], v[56:59]
    ds_read_b128 v[116:119], v5 offset:30720
    v_mfma_f32_16x16x32_bf16 v[88:91], v[144:147], v[120:123], v[88:91]
    s_waitcnt vmcnt(6)
    s_waitcnt lgkmcnt(6)
    v_mfma_f32_16x16x32_bf16 v[28:31], v[92:95], v[148:151], v[28:31]
    ds_read_b128 v[120:123], v5 offset:31744
    v_mfma_f32_16x16x32_bf16 v[60:63], v[92:95], v[152:155], v[60:63]
    s_waitcnt lgkmcnt(6)
    v_mfma_f32_16x16x32_bf16 v[32:35], v[96:99], v[148:151], v[32:35]
    ds_read_b128 v[92:95], v5 offset:32768
    v_mfma_f32_16x16x32_bf16 v[64:67], v[96:99], v[152:155], v[64:67]
    buffer_load_dwordx4 v[140:143], v3, s[4:7], s39 offen offset:2048 sc1
    s_waitcnt lgkmcnt(6)
    v_mfma_f32_16x16x32_bf16 v[36:39], v[100:103], v[148:151], v[36:39]
    ds_read_b128 v[96:99], v5 offset:33792
    v_mfma_f32_16x16x32_bf16 v[68:71], v[100:103], v[152:155], v[68:71]
    s_waitcnt lgkmcnt(6)
    v_mfma_f32_16x16x32_bf16 v[40:43], v[104:107], v[148:151], v[40:43]
    ds_read_b128 v[100:103], v5 offset:34816
    v_mfma_f32_16x16x32_bf16 v[72:75], v[104:107], v[152:155], v[72:75]
    s_waitcnt lgkmcnt(6)
    v_mfma_f32_16x16x32_bf16 v[44:47], v[108:111], v[148:151], v[44:47]
    ds_read_b128 v[104:107], v5 offset:35840
    v_mfma_f32_16x16x32_bf16 v[76:79], v[108:111], v[152:155], v[76:79]
    s_waitcnt lgkmcnt(6)
    v_mfma_f32_16x16x32_bf16 v[48:51], v[148:151], v[112:115], v[48:51]
    ds_read_b128 v[108:111], v5 offset:36864
    v_mfma_f32_16x16x32_bf16 v[80:83], v[152:155], v[112:115], v[80:83]
    buffer_load_dwordx4 v[144:147], v4, s[4:7], s39 offen offset:2048 sc1
    s_waitcnt lgkmcnt(6)
    v_mfma_f32_16x16x32_bf16 v[52:55], v[148:151], v[116:119], v[52:55]
    ds_read_b128 v[112:115], v5 offset:37888
    v_mfma_f32_16x16x32_bf16 v[84:87], v[152:155], v[116:119], v[84:87]
    s_waitcnt lgkmcnt(6)
    v_mfma_f32_16x16x32_bf16 v[56:59], v[148:151], v[120:123], v[56:59]
    ds_read_b128 v[116:119], v5 offset:38912
    v_mfma_f32_16x16x32_bf16 v[88:91], v[152:155], v[120:123], v[88:91]
    s_waitcnt vmcnt(6)
    s_waitcnt lgkmcnt(6)
    v_mfma_f32_16x16x32_bf16 v[28:31], v[92:95], v[156:159], v[28:31]
    ds_read_b128 v[120:123], v5 offset:39936
    v_mfma_f32_16x16x32_bf16 v[60:63], v[92:95], v[160:163], v[60:63]
    v_add_u32 v5, 40960, v5
    s_waitcnt lgkmcnt(6)
    v_mfma_f32_16x16x32_bf16 v[32:35], v[96:99], v[156:159], v[32:35]
    ds_read_b128 v[92:95], v5 offset:0
    v_mfma_f32_16x16x32_bf16 v[64:67], v[96:99], v[160:163], v[64:67]
    buffer_load_dwordx4 v[148:151], v3, s[4:7], s39 offen offset:3072 sc1
    s_waitcnt lgkmcnt(6)
    v_mfma_f32_16x16x32_bf16 v[36:39], v[100:103], v[156:159], v[36:39]
    ds_read_b128 v[96:99], v5 offset:1024
    v_mfma_f32_16x16x32_bf16 v[68:71], v[100:103], v[160:163], v[68:71]
    s_add_u32 s38, s38, 5120
    s_waitcnt lgkmcnt(6)
    v_mfma_f32_16x16x32_bf16 v[40:43], v[104:107], v[156:159], v[40:43]
    ds_read_b128 v[100:103], v5 offset:2048
    v_mfma_f32_16x16x32_bf16 v[72:75], v[104:107], v[160:163], v[72:75]
    s_add_u32 s23, s23, 1
    s_waitcnt lgkmcnt(6)
    v_mfma_f32_16x16x32_bf16 v[44:47], v[108:111], v[156:159], v[44:47]
    ds_read_b128 v[104:107], v5 offset:3072
    v_mfma_f32_16x16x32_bf16 v[76:79], v[108:111], v[160:163], v[76:79]
    s_waitcnt lgkmcnt(6)
    v_mfma_f32_16x16x32_bf16 v[48:51], v[156:159], v[112:115], v[48:51]
    ds_read_b128 v[108:111], v5 offset:4096
    v_mfma_f32_16x16x32_bf16 v[80:83], v[160:163], v[112:115], v[80:83]
    buffer_load_dwordx4 v[152:155], v4, s[4:7], s39 offen offset:3072 sc1
    s_waitcnt lgkmcnt(6)
    v_mfma_f32_16x16x32_bf16 v[52:55], v[156:159], v[116:119], v[52:55]
    ds_read_b128 v[112:115], v5 offset:5120
    v_mfma_f32_16x16x32_bf16 v[84:87], v[160:163], v[116:119], v[84:87]
    s_add_u32 s39, s38, 1024
    s_cmp_eq_u32 s23, 3
    s_cselect_b32 s39, s29, s39
    s_waitcnt lgkmcnt(6)
    v_mfma_f32_16x16x32_bf16 v[56:59], v[156:159], v[120:123], v[56:59]
    ds_read_b128 v[116:119], v5 offset:6144
    v_mfma_f32_16x16x32_bf16 v[88:91], v[160:163], v[120:123], v[88:91]
    s_cmp_lt_u32 s23, 4
    s_cbranch_scc1 L_g1a_loop
    s_waitcnt lgkmcnt(0)
    ds_bpermute_b32 v92, v7, v18 offset:0
    ds_bpermute_b32 v100, v7, v19 offset:0
    ds_bpermute_b32 v93, v7, v18 offset:4
    ds_bpermute_b32 v101, v7, v19 offset:4
    ds_bpermute_b32 v94, v7, v18 offset:8
    ds_bpermute_b32 v102, v7, v19 offset:8
    ds_bpermute_b32 v95, v7, v18 offset:12
    ds_bpermute_b32 v103, v7, v19 offset:12
    s_waitcnt lgkmcnt(7)
    ds_bpermute_b32 v96, v7, v22 offset:0
    ds_bpermute_b32 v104, v7, v23 offset:0
    ds_bpermute_b32 v97, v7, v22 offset:4
    ds_bpermute_b32 v105, v7, v23 offset:4
    ds_bpermute_b32 v98, v7, v22 offset:8
    ds_bpermute_b32 v106, v7, v23 offset:8
    ds_bpermute_b32 v99, v7, v22 offset:12
    ds_bpermute_b32 v107, v7, v23 offset:12
    s_waitcnt vmcnt(6)
    v_pk_fma_f32 v[28:29], v[124:125], v[18:19], v[28:29] op_sel_hi:[1,0,1] neg_lo:[0,1,0] neg_hi:[0,1,0]
    v_pk_fma_f32 v[30:31], v[126:127], v[18:19], v[30:31] op_sel_hi:[1,0,1] neg_lo:[0,1,0] neg_hi:[0,1,0]
    v_pk_mul_f32 v[28:29], v[28:29], v[20:21] op_sel_hi:[1,0]
    v_pk_mul_f32 v[30:31], v[30:31], v[20:21] op_sel_hi:[1,0]
    v_pk_fma_f32 v[60:61], v[124:125], v[22:23], v[60:61] op_sel_hi:[1,0,1] neg_lo:[0,1,0] neg_hi:[0,1,0]
    v_pk_fma_f32 v[62:63], v[126:127], v[22:23], v[62:63] op_sel_hi:[1,0,1] neg_lo:[0,1,0] neg_hi:[0,1,0]
    v_pk_mul_f32 v[60:61], v[60:61], v[24:25] op_sel_hi:[1,0]
    v_pk_mul_f32 v[62:63], v[62:63], v[24:25] op_sel_hi:[1,0]
    v_cvt_pk_bf16_f32 v28, v28, v29
    v_cvt_pk_bf16_f32 v29, v30, v31
    v_cvt_pk_bf16_f32 v30, v60, v61
    v_cvt_pk_bf16_f32 v31, v62, v63
    buffer_store_dwordx4 v[28:31], v6, s[4:7], 0 offen offset:0 sc1
    v_pk_fma_f32 v[32:33], v[128:129], v[18:19], v[32:33] op_sel_hi:[1,0,1] neg_lo:[0,1,0] neg_hi:[0,1,0]
    v_pk_fma_f32 v[34:35], v[130:131], v[18:19], v[34:35] op_sel_hi:[1,0,1] neg_lo:[0,1,0] neg_hi:[0,1,0]
    v_pk_mul_f32 v[32:33], v[32:33], v[20:21] op_sel_hi:[1,0]
    v_pk_mul_f32 v[34:35], v[34:35], v[20:21] op_sel_hi:[1,0]
    v_pk_fma_f32 v[64:65], v[128:129], v[22:23], v[64:65] op_sel_hi:[1,0,1] neg_lo:[0,1,0] neg_hi:[0,1,0]
    v_pk_fma_f32 v[66:67], v[130:131], v[22:23], v[66:67] op_sel_hi:[1,0,1] neg_lo:[0,1,0] neg_hi:[0,1,0]
    v_pk_mul_f32 v[64:65], v[64:65], v[24:25] op_sel_hi:[1,0]
    v_pk_mul_f32 v[66:67], v[66:67], v[24:25] op_sel_hi:[1,0]
    v_cvt_pk_bf16_f32 v32, v32, v33
    v_cvt_pk_bf16_f32 v33, v34, v35
    v_cvt_pk_bf16_f32 v34, v64, v65
    v_cvt_pk_bf16_f32 v35, v66, v67
    buffer_store_dwordx4 v[32:35], v6, s[4:7], 0 offen offset:512 sc1
    s_waitcnt vmcnt(6)
    v_pk_fma_f32 v[36:37], v[132:133], v[18:19], v[36:37] op_sel_hi:[1,0,1] neg_lo:[0,1,0] neg_hi:[0,1,0]
    v_pk_fma_f32 v[38:39], v[134:135], v[18:19], v[38:39] op_sel_hi:[1,0,1] neg_lo:[0,1,0] neg_hi:[0,1,0]
    v_pk_mul_f32 v[36:37], v[36:37], v[20:21] op_sel_hi:[1,0]
    v_pk_mul_f32 v[38:39], v[38:39], v[20:21] op_sel_hi:[1,0]
    v_pk_fma_f32 v[68:69], v[132:133], v[22:23], v[68:69] op_sel_hi:[1,0,1] neg_lo:[0,1,0] neg_hi:[0,1,0]
    v_pk_fma_f32 v[70:71], v[134:135], v[22:23], v[70:71] op_sel_hi:[1,0,1] neg_lo:[0,1,0] neg_hi:[0,1,0]
    v_pk_mul_f32 v[68:69], v[68:69], v[24:25] op_sel_hi:[1,0]
    v_pk_mul_f32 v[70:71], v[70:71], v[24:25] op_sel_hi:[1,0]
    v_cvt_pk_bf16_f32 v36, v36, v37
    v_cvt_pk_bf16_f32 v37, v38, v39
    v_cvt_pk_bf16_f32 v38, v68, v69
    v_cvt_pk_bf16_f32 v39, v70, v71
    buffer_store_dwordx4 v[36:39], v6, s[4:7], 0 offen offset:256 sc1
    v_pk_fma_f32 v[40:41], v[136:137], v[18:19], v[40:41] op_sel_hi:[1,0,1] neg_lo:[0,1,0] neg_hi:[0,1,0]
    v_pk_fma_f32 v[42:43], v[138:139], v[18:19], v[42:43] op_sel_hi:[1,0,1] neg_lo:[0,1,0] neg_hi:[0,1,0]
    v_pk_mul_f32 v[40:41], v[40:41], v[20:21] op_sel_hi:[1,0]
    v_pk_mul_f32 v[42:43], v[42:43], v[20:21] op_sel_hi:[1,0]
    v_pk_fma_f32 v[72:73], v[136:137], v[22:23], v[72:73] op_sel_hi:[1,0,1] neg_lo:[0,1,0] neg_hi:[0,1,0]
    v_pk_fma_f32 v[74:75], v[138:139], v[22:23], v[74:75] op_sel_hi:[1,0,1] neg_lo:[0,1,0] neg_hi:[0,1,0]
    v_pk_mul_f32 v[72:73], v[72:73], v[24:25] op_sel_hi:[1,0]
    v_pk_mul_f32 v[74:75], v[74:75], v[24:25] op_sel_hi:[1,0]
    v_cvt_pk_bf16_f32 v40, v40, v41
    v_cvt_pk_bf16_f32 v41, v42, v43
    v_cvt_pk_bf16_f32 v42, v72, v73
    v_cvt_pk_bf16_f32 v43, v74, v75
    buffer_store_dwordx4 v[40:43], v6, s[4:7], 0 offen offset:768 sc1
    s_waitcnt vmcnt(6)
    v_pk_fma_f32 v[44:45], v[140:141], v[18:19], v[44:45] op_sel_hi:[1,0,1] neg_lo:[0,1,0] neg_hi:[0,1,0]
    v_pk_fma_f32 v[46:47], v[142:143], v[18:19], v[46:47] op_sel_hi:[1,0,1] neg_lo:[0,1,0] neg_hi:[0,1,0]
    v_pk_mul_f32 v[44:45], v[44:45], v[20:21] op_sel_hi:[1,0]
    v_pk_mul_f32 v[46:47], v[46:47], v[20:21] op_sel_hi:[1,0]
    v_pk_fma_f32 v[76:77], v[140:141], v[22:23], v[76:77] op_sel_hi:[1,0,1] neg_lo:[0,1,0] neg_hi:[0,1,0]
    v_pk_fma_f32 v[78:79], v[142:143], v[22:23], v[78:79] op_sel_hi:[1,0,1] neg_lo:[0,1,0] neg_hi:[0,1,0]
    v_pk_mul_f32 v[76:77], v[76:77], v[24:25] op_sel_hi:[1,0]
    v_pk_mul_f32 v[78:79], v[78:79], v[24:25] op_sel_hi:[1,0]
    v_cvt_pk_bf16_f32 v44, v44, v45
    v_cvt_pk_bf16_f32 v45, v46, v47
    v_cvt_pk_bf16_f32 v46, v76, v77
    v_cvt_pk_bf16_f32 v47, v78, v79
    buffer_store_dwordx4 v[44:47], v6, s[4:7], 0 offen offset:1024 sc1
    s_waitcnt lgkmcnt(0)
    v_pk_fma_f32 v[48:49], v[92:93], v[144:145], v[48:49] op_sel_hi:[1,0,1] neg_lo:[1,0,0] neg_hi:[1,0,0]
    v_pk_fma_f32 v[50:51], v[94:95], v[144:145], v[50:51] op_sel_hi:[1,0,1] neg_lo:[1,0,0] neg_hi:[1,0,0]
    v_pk_mul_f32 v[48:49], v[48:49], v[100:101]
    v_pk_mul_f32 v[50:51], v[50:51], v[102:103]
    v_pk_fma_f32 v[80:81], v[96:97], v[144:145], v[80:81] op_sel_hi:[1,0,1] neg_lo:[1,0,0] neg_hi:[1,0,0]
    v_pk_fma_f32 v[82:83], v[98:99], v[144:145], v[82:83] op_sel_hi:[1,0,1] neg_lo:[1,0,0] neg_hi:[1,0,0]
    v_pk_mul_f32 v[80:81], v[80:81], v[104:105]
    v_pk_mul_f32 v[82:83], v[82:83], v[106:107]
    v_cvt_pk_bf16_f32 v48, v48, v80
    v_cvt_pk_bf16_f32 v49, v49, v81
    v_cvt_pk_bf16_f32 v50, v50, v82
    v_cvt_pk_bf16_f32 v51, v51, v83
    s_nop 1
    v_permlane16_swap_b32 v48, v50
    v_permlane16_swap_b32 v49, v51
    buffer_store_dwordx4 v[48:51], v8, s[4:7], 0 offen sc1
    s_waitcnt vmcnt(6)
    v_pk_fma_f32 v[52:53], v[92:93], v[148:149], v[52:53] op_sel_hi:[1,0,1] neg_lo:[1,0,0] neg_hi:[1,0,0]
    v_pk_fma_f32 v[54:55], v[94:95], v[148:149], v[54:55] op_sel_hi:[1,0,1] neg_lo:[1,0,0] neg_hi:[1,0,0]
    v_pk_mul_f32 v[52:53], v[52:53], v[100:101]
    v_pk_mul_f32 v[54:55], v[54:55], v[102:103]
    v_pk_fma_f32 v[84:85], v[96:97], v[148:149], v[84:85] op_sel_hi:[1,0,1] neg_lo:[1,0,0] neg_hi:[1,0,0]
    v_pk_fma_f32 v[86:87], v[98:99], v[148:149], v[86:87] op_sel_hi:[1,0,1] neg_lo:[1,0,0] neg_hi:[1,0,0]
    v_pk_mul_f32 v[84:85], v[84:85], v[104:105]
    v_pk_mul_f32 v[86:87], v[86:87], v[106:107]
    v_cvt_pk_bf16_f32 v52, v52, v84
    v_cvt_pk_bf16_f32 v53, v53, v85
    v_cvt_pk_bf16_f32 v54, v54, v86
    v_cvt_pk_bf16_f32 v55, v55, v87
    s_nop 1
    v_permlane16_swap_b32 v52, v54
    v_permlane16_swap_b32 v53, v55
    buffer_store_dwordx4 v[52:55], v9, s[4:7], 0 offen sc1
    v_pk_fma_f32 v[56:57], v[92:93], v[152:153], v[56:57] op_sel_hi:[1,0,1] neg_lo:[1,0,0] neg_hi:[1,0,0]
    v_pk_fma_f32 v[58:59], v[94:95], v[152:153], v[58:59] op_sel_hi:[1,0,1] neg_lo:[1,0,0] neg_hi:[1,0,0]
    v_pk_mul_f32 v[56:57], v[56:57], v[100:101]
    v_pk_mul_f32 v[58:59], v[58:59], v[102:103]
    v_pk_fma_f32 v[88:89], v[96:97], v[152:153], v[88:89] op_sel_hi:[1,0,1] neg_lo:[1,0,0] neg_hi:[1,0,0]
    v_pk_fma_f32 v[90:91], v[98:99], v[152:153], v[90:91] op_sel_hi:[1,0,1] neg_lo:[1,0,0] neg_hi:[1,0,0]
    v_pk_mul_f32 v[88:89], v[88:89], v[104:105]
    v_pk_mul_f32 v[90:91], v[90:91], v[106:107]
    v_cvt_pk_bf16_f32 v56, v56, v88
    v_cvt_pk_bf16_f32 v57, v57, v89
    v_cvt_pk_bf16_f32 v58, v58, v90
    v_cvt_pk_bf16_f32 v59, v59, v91
    s_nop 1
    v_permlane16_swap_b32 v56, v58
    v_permlane16_swap_b32 v57, v59
    buffer_store_dwordx4 v[56:59], v10, s[4:7], 0 offen sc1
    s_barrier
    s_lshl_b32 s28, s21, 2
    s_and_b32 s29, s20, 3
    s_add_u32 s28, s28, s29
    s_add_u32 s28, s28, 960
    s_lshl_b32 s60, s28, 7
    v_mul_u32_u24 v1, 139264, v0
    v_add_u32 v1, s60, v1
    v_mov_b32 v2, 1
    s_waitcnt vmcnt(0)
    s_mov_b64 exec, 1
    buffer_atomic_add v2, v1, s[4:7], 0 offen sc1
    s_mov_b64 exec, -1
    s_branch L_at
L_g2:
    s_cmp_lt_u32 s3, 4
    s_cbranch_scc1 L_g2_comp
    s_cmp_ge_u32 s3, 8
    s_cbranch_scc1 L_g2_h
    s_barrier
    s_cmp_eq_u32 s92, 3
    s_cbranch_scc1 L_fin
    s_barrier
    s_branch L_g2_next
L_g2_h:
    s_waitcnt vmcnt(0)
    s_barrier
    s_cmp_eq_u32 s92, 3
    s_cbranch_scc1 L_fin
    s_and_b32 s25, s2, 1
    s_lshl_b32 s25, s25, 3
    s_lshr_b32 s30, s2, 5
    s_add_u32 s25, s25, s30
    s_mul_i32 s27, s25, 163840
    s_cmp_eq_u32 s92, 1
    s_cselect_b32 s28, 0, 2621440
    s_cselect_b32 s41, 6, 2
    s_cselect_b32 s42, 19, 15
    s_add_u32 s27, s27, s28
    s_add_u32 s27, s27, 860160
    s_mov_b32 s40, 0
    s_mov_b32 s43, 20
    s_cmp_eq_u32 s92, 1
    s_cselect_b32 s44, 0, 122880
    s_cselect_b32 s45, 0, 163840
    s_sub_u32 s27, s27, s44
    s_add_u32 s28, s3, s42
    s_sub_u32 s28, s28, 8
    s_add_u32 s23, s43, 1
    s_sub_u32 s23, s23, s28
    s_lshr_b32 s23, s23, 1
    s_lshl_b32 s28, s28, 13
    s_add_u32 s24, s27, s28
    s_mov_b32 m0, s28
    s_cmp_eq_u32 s23, 0
    s_cbranch_scc1 L_g2_e1_x
L_g2_e1:
    buffer_load_dwordx4 v1, s[4:7], s24 offen offset:0 sc1 lds
    buffer_load_dwordx4 v1, s[4:7], s24 offen offset:1024 sc1 lds
    buffer_load_dwordx4 v1, s[4:7], s24 offen offset:2048 sc1 lds
    buffer_load_dwordx4 v1, s[4:7], s24 offen offset:3072 sc1 lds
    s_add_u32 m0, m0, 4096
    s_add_u32 s24, s24, 4096
    buffer_load_dwordx4 v1, s[4:7], s24 offen offset:0 sc1 lds
    buffer_load_dwordx4 v1, s[4:7], s24 offen offset:1024 sc1 lds
    buffer_load_dwordx4 v1, s[4:7], s24 offen offset:2048 sc1 lds
    buffer_load_dwordx4 v1, s[4:7], s24 offen offset:3072 sc1 lds
    s_add_u32 m0, m0, 4096
    s_add_u32 s24, s24, 4096
    s_add_u32 m0, m0, 8192
    s_add_u32 s24, s24, 8192
    s_sub_u32 s23, s23, 1
    s_cmp_lg_u32 s23, 0
    s_cbranch_scc1 L_g2_e1
L_g2_e1_x:
    s_add_u32 s27, s27, s45
    s_add_u32 s28, s3, s40
    s_sub_u32 s28, s28, 8
    s_add_u32 s23, s41, 1
    s_sub_u32 s23, s23, s28
    s_lshr_b32 s23, s23, 1
    s_lshl_b32 s28, s28, 13
    s_add_u32 s24, s27, s28
    s_mov_b32 m0, s28
    s_cmp_eq_u32 s23, 0
    s_cbranch_scc1 L_g2_e0_x
L_g2_e0:
    buffer_load_dwordx4 v1, s[4:7], s24 offen offset:0 sc1 lds
    buffer_load_dwordx4 v1, s[4:7], s24 offen offset:1024 sc1 lds
    buffer_load_dwordx4 v1, s[4:7], s24 offen offset:2048 sc1 lds
    buffer_load_dwordx4 v1, s[4:7], s24 offen offset:3072 sc1 lds
    s_add_u32 m0, m0, 4096
    s_add_u32 s24, s24, 4096
    buffer_load_dwordx4 v1, s[4:7], s24 offen offset:0 sc1 lds
    buffer_load_dwordx4 v1, s[4:7], s24 offen offset:1024 sc1 lds
    buffer_load_dwordx4 v1, s[4:7], s24 offen offset:2048 sc1 lds
    buffer_load_dwordx4 v1, s[4:7], s24 offen offset:3072 sc1 lds
    s_add_u32 m0, m0, 4096
    s_add_u32 s24, s24, 4096
    s_add_u32 m0, m0, 8192
    s_add_u32 s24, s24, 8192
    s_sub_u32 s23, s23, 1
    s_cmp_lg_u32 s23, 0
    s_cbranch_scc1 L_g2_e0
L_g2_e0_x:
    s_waitcnt vmcnt(0)
    s_barrier
    s_add_u32 s28, s3, s41
    s_sub_u32 s28, s28, 8
    s_add_u32 s23, s42, 1
    s_sub_u32 s23, s23, s28
    s_lshr_b32 s23, s23, 1
    s_lshl_b32 s28, s28, 13
    s_add_u32 s24, s27, s28
    s_mov_b32 m0, s28
    s_cmp_eq_u32 s23, 0
    s_cbranch_scc1 L_g2_l_x
L_g2_l:
    buffer_load_dwordx4 v1, s[4:7], s24 offen offset:0 sc1 lds
    buffer_load_dwordx4 v1, s[4:7], s24 offen offset:1024 sc1 lds
    buffer_load_dwordx4 v1, s[4:7], s24 offen offset:2048 sc1 lds
    buffer_load_dwordx4 v1, s[4:7], s24 offen offset:3072 sc1 lds
    s_add_u32 m0, m0, 4096
    s_add_u32 s24, s24, 4096
    buffer_load_dwordx4 v1, s[4:7], s24 offen offset:0 sc1 lds
    buffer_load_dwordx4 v1, s[4:7], s24 offen offset:1024 sc1 lds
    buffer_load_dwordx4 v1, s[4:7], s24 offen offset:2048 sc1 lds
    buffer_load_dwordx4 v1, s[4:7], s24 offen offset:3072 sc1 lds
    s_add_u32 m0, m0, 4096
    s_add_u32 s24, s24, 4096
    s_add_u32 m0, m0, 8192
    s_add_u32 s24, s24, 8192
    s_sub_u32 s23, s23, 1
    s_cmp_lg_u32 s23, 0
    s_cbranch_scc1 L_g2_l
L_g2_l_x:
    s_branch L_g2_next
L_g2_comp:
    s_bfe_u32 s20, s2, 0x20001
    s_lshl_b32 s20, s20, 3
    s_bfe_u32 s28, s2, 0x30003
    s_add_u32 s20, s20, s28
    s_and_b32 s21, s2, 1
    s_lshl_b32 s21, s21, 2
    s_lshr_b32 s28, s2, 6
    s_add_u32 s21, s21, s28
    v_and_b32 v1, 15, v0
    v_lshrrev_b32 v2, 4, v0
    s_lshl_b32 s36, s20, 2
    s_add_u32 s36, s36, s3
    s_mul_i32 s37, s36, 20480
    s_mul_i32 s38, s92, 2621440
    s_add_u32 s48, s37, s38
    s_add_u32 s48, s48, 23470080
    v_lshlrev_b32 v3, 4, v0
    s_lshl_b32 s28, s36, 4
    v_add_u32 v12, s28, v1
    v_mul_u32_u24 v12, 1280, v12
    s_mul_i32 s28, s21, 160
    v_add_u32 v12, s28, v12
    v_lshl_add_u32 v6, v2, 4, v12
    v_lshl_add_u32 v7, v2, 3, v12
    v_add_u32 v7, 128, v7
    s_mul_i32 s28, s21, 2560
    s_add_u32 s28, s28, s37
    s_add_u32 s28, s28, s38
    s_add_u32 s28, s28, 33955840
    v_add_u32 v8, s28, v3
    v_lshrrev_b32 v12, 1, v2
    v_lshlrev_b32 v12, 8, v12
    v_lshl_add_u32 v12, v1, 4, v12
    v_and_b32 v13, 1, v2
    v_lshl_add_u32 v12, v13, 3, v12
    s_add_u32 s28, s28, 2048
    v_add_u32 v9, s28, v12
    v_subrev_u32 v10, 2621440, v8
    v_subrev_u32 v11, 2621440, v9
    s_cmp_eq_u32 s92, 0
    s_cselect_b32 s8, s62, s4
    s_cselect_b32 s9, s63, s5
    s_cselect_b32 s10, 2621440, s6
    s_mov_b32 s11, 0x20000
    s_cselect_b64 vcc, -1, 0
    s_cselect_b32 s30, 64, 1024
    v_cndmask_b32 v10, v10, v6, vcc
    v_cndmask_b32 v11, v11, v7, vcc
    buffer_load_dwordx4 v[152:155], v10, s[8:11], 0 offen sc1
    buffer_load_dwordx4 v[156:159], v10, s[8:11], s30 offen sc1
    buffer_load_dwordx2 v[160:161], v11, s[8:11], 0 offen sc1
    s_and_b32 s28, s92, 1
    s_mul_i32 s28, s28, 30720
    s_add_u32 s28, s28, 20480
    v_add_u32 v4, s28, v3
    v_add_u32 v5, 61440, v4
    s_lshl_b32 s35, s92, 7
    s_add_u32 s35, s35, s36
    s_and_b32 s28, s35, 0xfffe
    s_add_u32 s28, s28, 64
    s_mov_b32 s39, s28
    v_add_u32 v10, s28, v0
    v_lshlrev_b32 v10, 7, v10
    s_lshl_b32 s34, s35, 10
    s_lshl_b32 s28, s21, 7
    s_add_u32 s34, s34, s28
    s_add_u32 s34, s34, 139264
    s_add_u32 s35, s35, 576
    s_add_u32 s49, s48, 4096
    s_add_u32 s50, s48, 8192
    s_add_u32 s51, s48, 12288
    s_add_u32 s52, s48, 16384
    s_barrier
    ds_read_b128 v[112:115], v4 offset:0
    ds_read_b128 v[116:119], v4 offset:1024
    ds_read_b128 v[120:123], v4 offset:2048
    ds_read_b128 v[124:127], v4 offset:3072
    ds_read_b128 v[128:131], v4 offset:4096
    ds_read_b128 v[132:135], v4 offset:5120
    ds_read_b128 v[136:139], v4 offset:6144
    ds_read_b128 v[140:143], v4 offset:7168
    ds_read_b128 v[144:147], v4 offset:8192
    ds_read_b128 v[148:151], v4 offset:9216
    s_waitcnt vmcnt(0)
    v_lshlrev_b32 v12, 16, v152
    v_and_b32 v13, 0xffff0000, v152
    v_lshlrev_b32 v14, 16, v153
    v_and_b32 v15, 0xffff0000, v153
    v_lshlrev_b32 v16, 16, v154
    v_and_b32 v17, 0xffff0000, v154
    v_lshlrev_b32 v18, 16, v155
    v_and_b32 v19, 0xffff0000, v155
    v_lshlrev_b32 v20, 16, v156
    v_and_b32 v21, 0xffff0000, v156
    v_lshlrev_b32 v22, 16, v157
    v_and_b32 v23, 0xffff0000, v157
    v_lshlrev_b32 v24, 16, v158
    v_and_b32 v25, 0xffff0000, v158
    v_lshlrev_b32 v26, 16, v159
    v_and_b32 v27, 0xffff0000, v159
    v_lshlrev_b32 v28, 16, v160
    v_and_b32 v29, 0xffff0000, v160
    v_lshlrev_b32 v30, 16, v161
    v_and_b32 v31, 0xffff0000, v161
    v_mov_b32 v164, 1065369472
    v_mov_b32 v165, 1065369472
    v_mov_b32 v166, 1065369472
    v_mov_b32 v167, 1065369472
    v_mov_b32 v162, 0
    v_mov_b32 v163, 0
    v_lshlrev_b32 v11, 8, v2
    v_lshl_add_u32 v11, v1, 3, v11
    v_and_b32 v2, 3, v1
    v_cmp_eq_u32 s[40:41], 1, v2
    v_cmp_eq_u32 s[42:43], 2, v2
    v_cmp_eq_u32 s[44:45], 3, v2
    s_lshl_b32 s60, s39, 7
    s_add_u32 s58, s4, s60
    s_addc_u32 s59, s5, 0
    s_mov_b32 s61, 0
L_g2_poll:
    s_mov_b32 s16, 0
    s_mov_b32 s17, 0
    s_atomic_add s16, s[58:59], 0 glc
    s_atomic_add s17, s[58:59], 128 glc
    s_add_u32 s61, s61, 1
    s_waitcnt lgkmcnt(0)
    s_min_u32 s16, s16, s17
    s_cmp_ge_u32 s16, 16
    s_cbranch_scc1 L_g2_poll_ok
    s_cmp_lt_u32 s61, 200000
    s_cbranch_scc1 L_g2_poll
L_g2_poll_ok:
    buffer_load_dwordx4 v[32:35], v3, s[4:7], s48 offen offset:0 sc1
    buffer_load_dwordx4 v[36:39], v3, s[4:7], s48 offen offset:1024 sc1
    buffer_load_dwordx4 v[40:43], v3, s[4:7], s48 offen offset:2048 sc1
    buffer_load_dwordx4 v[44:47], v3, s[4:7], s48 offen offset:3072 sc1
    buffer_load_dwordx4 v[48:51], v3, s[4:7], s49 offen offset:0 sc1
    buffer_load_dwordx4 v[52:55], v3, s[4:7], s49 offen offset:1024 sc1
    buffer_load_dwordx4 v[56:59], v3, s[4:7], s49 offen offset:2048 sc1
    buffer_load_dwordx4 v[60:63], v3, s[4:7], s49 offen offset:3072 sc1
    s_waitcnt vmcnt(7)
    buffer_load_dwordx4 v[64:67], v3, s[4:7], s50 offen offset:0 sc1
    s_waitcnt lgkmcnt(9)
    v_mfma_f32_16x16x32_bf16 v[12:15], v[112:115], v[32:35], v[12:15]
    ds_read_b128 v[112:115], v4 offset:10240
    s_waitcnt lgkmcnt(9)
    v_mfma_f32_16x16x32_bf16 v[16:19], v[116:119], v[32:35], v[16:19]
    ds_read_b128 v[116:119], v4 offset:11264
    s_waitcnt lgkmcnt(9)
    v_mfma_f32_16x16x32_bf16 v[20:23], v[120:123], v[32:35], v[20:23]
    ds_read_b128 v[120:123], v4 offset:12288
    s_waitcnt lgkmcnt(9)
    v_mfma_f32_16x16x32_bf16 v[24:27], v[124:127], v[32:35], v[24:27]
    ds_read_b128 v[124:127], v4 offset:13312
    s_waitcnt lgkmcnt(9)
    v_mfma_f32_16x16x32_bf16 v[28:31], v[128:131], v[32:35], v[28:31]
    ds_read_b128 v[128:131], v4 offset:14336
    s_waitcnt vmcnt(7)
    buffer_load_dwordx4 v[68:71], v3, s[4:7], s50 offen offset:1024 sc1
    s_waitcnt lgkmcnt(9)
    v_mfma_f32_16x16x32_bf16 v[12:15], v[132:135], v[36:39], v[12:15]
    ds_read_b128 v[132:135], v4 offset:15360
    s_waitcnt lgkmcnt(9)
    v_mfma_f32_16x16x32_bf16 v[16:19], v[136:139], v[36:39], v[16:19]
    ds_read_b128 v[136:139], v4 offset:16384
    s_waitcnt lgkmcnt(9)
    v_mfma_f32_16x16x32_bf16 v[20:23], v[140:143], v[36:39], v[20:23]
    ds_read_b128 v[140:143], v4 offset:17408
    s_waitcnt lgkmcnt(9)
    v_mfma_f32_16x16x32_bf16 v[24:27], v[144:147], v[36:39], v[24:27]
    ds_read_b128 v[144:147], v4 offset:18432
    s_waitcnt lgkmcnt(9)
    v_mfma_f32_16x16x32_bf16 v[28:31], v[148:151], v[36:39], v[28:31]
    ds_read_b128 v[148:151], v4 offset:19456
    s_waitcnt vmcnt(7)
    buffer_load_dwordx4 v[72:75], v3, s[4:7], s50 offen offset:2048 sc1
    s_waitcnt lgkmcnt(9)
    v_mfma_f32_16x16x32_bf16 v[12:15], v[112:115], v[40:43], v[12:15]
    ds_read_b128 v[112:115], v4 offset:20480
    s_waitcnt lgkmcnt(9)
    v_mfma_f32_16x16x32_bf16 v[16:19], v[116:119], v[40:43], v[16:19]
    ds_read_b128 v[116:119], v4 offset:21504
    s_waitcnt lgkmcnt(9)
    v_mfma_f32_16x16x32_bf16 v[20:23], v[120:123], v[40:43], v[20:23]
    ds_read_b128 v[120:123], v4 offset:22528
    s_waitcnt lgkmcnt(9)
    v_mfma_f32_16x16x32_bf16 v[24:27], v[124:127], v[40:43], v[24:27]
    ds_read_b128 v[124:127], v4 offset:23552
    s_waitcnt lgkmcnt(9)
    v_mfma_f32_16x16x32_bf16 v[28:31], v[128:131], v[40:43], v[28:31]
    ds_read_b128 v[128:131], v4 offset:24576
    s_waitcnt vmcnt(7)
    buffer_load_dwordx4 v[76:79], v3, s[4:7], s50 offen offset:3072 sc1
    s_waitcnt lgkmcnt(9)
    v_mfma_f32_16x16x32_bf16 v[12:15], v[132:135], v[44:47], v[12:15]
    ds_read_b128 v[132:135], v4 offset:25600
    s_waitcnt lgkmcnt(9)
    v_mfma_f32_16x16x32_bf16 v[16:19], v[136:139], v[44:47], v[16:19]
    ds_read_b128 v[136:139], v4 offset:26624
    s_waitcnt lgkmcnt(9)
    v_mfma_f32_16x16x32_bf16 v[20:23], v[140:143], v[44:47], v[20:23]
    ds_read_b128 v[140:143], v4 offset:27648
    s_waitcnt lgkmcnt(9)
    v_mfma_f32_16x16x32_bf16 v[24:27], v[144:147], v[44:47], v[24:27]
    ds_read_b128 v[144:147], v4 offset:28672
    s_waitcnt lgkmcnt(9)
    v_mfma_f32_16x16x32_bf16 v[28:31], v[148:151], v[44:47], v[28:31]
    ds_read_b128 v[148:151], v4 offset:29696
    s_waitcnt vmcnt(7)
    buffer_load_dwordx4 v[80:83], v3, s[4:7], s51 offen offset:0 sc1
    s_waitcnt lgkmcnt(9)
    v_mfma_f32_16x16x32_bf16 v[12:15], v[112:115], v[48:51], v[12:15]
    ds_read_b128 v[112:115], v4 offset:30720
    s_waitcnt lgkmcnt(9)
    v_mfma_f32_16x16x32_bf16 v[16:19], v[116:119], v[48:51], v[16:19]
    ds_read_b128 v[116:119], v4 offset:31744
    s_waitcnt lgkmcnt(9)
    v_mfma_f32_16x16x32_bf16 v[20:23], v[120:123], v[48:51], v[20:23]
    ds_read_b128 v[120:123], v4 offset:32768
    s_waitcnt lgkmcnt(9)
    v_mfma_f32_16x16x32_bf16 v[24:27], v[124:127], v[48:51], v[24:27]
    ds_read_b128 v[124:127], v4 offset:33792
    s_waitcnt lgkmcnt(9)
    v_mfma_f32_16x16x32_bf16 v[28:31], v[128:131], v[48:51], v[28:31]
    ds_read_b128 v[128:131], v4 offset:34816
    s_waitcnt vmcnt(7)
    buffer_load_dwordx4 v[84:87], v3, s[4:7], s51 offen offset:1024 sc1
    s_waitcnt lgkmcnt(9)
    v_mfma_f32_16x16x32_bf16 v[12:15], v[132:135], v[52:55], v[12:15]
    ds_read_b128 v[132:135], v4 offset:35840
    s_waitcnt lgkmcnt(9)
    v_mfma_f32_16x16x32_bf16 v[16:19], v[136:139], v[52:55], v[16:19]
    ds_read_b128 v[136:139], v4 offset:36864
    s_waitcnt lgkmcnt(9)
    v_mfma_f32_16x16x32_bf16 v[20:23], v[140:143], v[52:55], v[20:23]
    ds_read_b128 v[140:143], v4 offset:37888
    s_waitcnt lgkmcnt(9)
    v_mfma_f32_16x16x32_bf16 v[24:27], v[144:147], v[52:55], v[24:27]
    ds_read_b128 v[144:147], v4 offset:38912
    s_waitcnt lgkmcnt(9)
    v_mfma_f32_16x16x32_bf16 v[28:31], v[148:151], v[52:55], v[28:31]
    ds_read_b128 v[148:151], v4 offset:39936
    s_waitcnt vmcnt(7)
    buffer_load_dwordx4 v[88:91], v3, s[4:7], s51 offen offset:2048 sc1
    s_waitcnt lgkmcnt(9)
    v_mfma_f32_16x16x32_bf16 v[12:15], v[112:115], v[56:59], v[12:15]
    ds_read_b128 v[112:115], v4 offset:40960
    s_waitcnt lgkmcnt(9)
    v_mfma_f32_16x16x32_bf16 v[16:19], v[116:119], v[56:59], v[16:19]
    ds_read_b128 v[116:119], v4 offset:41984
    s_waitcnt lgkmcnt(9)
    v_mfma_f32_16x16x32_bf16 v[20:23], v[120:123], v[56:59], v[20:23]
    ds_read_b128 v[120:123], v4 offset:43008
    s_waitcnt lgkmcnt(9)
    v_mfma_f32_16x16x32_bf16 v[24:27], v[124:127], v[56:59], v[24:27]
    ds_read_b128 v[124:127], v4 offset:44032
    s_waitcnt lgkmcnt(9)
    v_mfma_f32_16x16x32_bf16 v[28:31], v[128:131], v[56:59], v[28:31]
    ds_read_b128 v[128:131], v4 offset:45056
    s_waitcnt vmcnt(7)
    buffer_load_dwordx4 v[92:95], v3, s[4:7], s51 offen offset:3072 sc1
    s_waitcnt lgkmcnt(9)
    v_mfma_f32_16x16x32_bf16 v[12:15], v[132:135], v[60:63], v[12:15]
    ds_read_b128 v[132:135], v4 offset:46080
    s_waitcnt lgkmcnt(9)
    v_mfma_f32_16x16x32_bf16 v[16:19], v[136:139], v[60:63], v[16:19]
    ds_read_b128 v[136:139], v4 offset:47104
    s_waitcnt lgkmcnt(9)
    v_mfma_f32_16x16x32_bf16 v[20:23], v[140:143], v[60:63], v[20:23]
    ds_read_b128 v[140:143], v4 offset:48128
    s_waitcnt lgkmcnt(9)
    v_mfma_f32_16x16x32_bf16 v[24:27], v[144:147], v[60:63], v[24:27]
    ds_read_b128 v[144:147], v4 offset:49152
    s_waitcnt lgkmcnt(9)
    v_mfma_f32_16x16x32_bf16 v[28:31], v[148:151], v[60:63], v[28:31]
    ds_read_b128 v[148:151], v4 offset:50176
    s_waitcnt vmcnt(7)
    buffer_load_dwordx2 v[96:97], v11, s[4:7], s52 offen offset:0 sc1
    buffer_load_dwordx2 v[98:99], v11, s[4:7], s52 offen offset:128 sc1
    s_waitcnt lgkmcnt(9)
    v_mfma_f32_16x16x32_bf16 v[12:15], v[112:115], v[64:67], v[12:15]
    ds_read_b128 v[112:115], v4 offset:51200
    s_waitcnt lgkmcnt(9)
    v_mfma_f32_16x16x32_bf16 v[16:19], v[116:119], v[64:67], v[16:19]
    ds_read_b128 v[116:119], v4 offset:52224
    s_waitcnt lgkmcnt(9)
    v_mfma_f32_16x16x32_bf16 v[20:23], v[120:123], v[64:67], v[20:23]
    ds_read_b128 v[120:123], v4 offset:53248
    s_waitcnt lgkmcnt(9)
    v_mfma_f32_16x16x32_bf16 v[24:27], v[124:127], v[64:67], v[24:27]
    ds_read_b128 v[124:127], v4 offset:54272
    s_waitcnt lgkmcnt(9)
    v_mfma_f32_16x16x32_bf16 v[28:31], v[128:131], v[64:67], v[28:31]
    ds_read_b128 v[128:131], v4 offset:55296
    s_waitcnt vmcnt(8)
    buffer_load_dwordx2 v[100:101], v11, s[4:7], s52 offen offset:1024 sc1
    buffer_load_dwordx2 v[102:103], v11, s[4:7], s52 offen offset:1152 sc1
    s_waitcnt lgkmcnt(9)
    v_mfma_f32_16x16x32_bf16 v[12:15], v[132:135], v[68:71], v[12:15]
    ds_read_b128 v[132:135], v4 offset:56320
    s_waitcnt lgkmcnt(9)
    v_mfma_f32_16x16x32_bf16 v[16:19], v[136:139], v[68:71], v[16:19]
    ds_read_b128 v[136:139], v4 offset:57344
    s_waitcnt lgkmcnt(9)
    v_mfma_f32_16x16x32_bf16 v[20:23], v[140:143], v[68:71], v[20:23]
    ds_read_b128 v[140:143], v4 offset:58368
    s_waitcnt lgkmcnt(9)
    v_mfma_f32_16x16x32_bf16 v[24:27], v[144:147], v[68:71], v[24:27]
    ds_read_b128 v[144:147], v4 offset:59392
    s_waitcnt lgkmcnt(9)
    v_mfma_f32_16x16x32_bf16 v[28:31], v[148:151], v[68:71], v[28:31]
    ds_read_b128 v[148:151], v4 offset:60416
    s_waitcnt vmcnt(9)
    buffer_load_dwordx2 v[104:105], v11, s[4:7], s52 offen offset:2048 sc1
    buffer_load_dwordx2 v[106:107], v11, s[4:7], s52 offen offset:2176 sc1
    s_waitcnt lgkmcnt(9)
    v_mfma_f32_16x16x32_bf16 v[12:15], v[112:115], v[72:75], v[12:15]
    ds_read_b128 v[112:115], v5 offset:0
    s_waitcnt lgkmcnt(9)
    v_mfma_f32_16x16x32_bf16 v[16:19], v[116:119], v[72:75], v[16:19]
    ds_read_b128 v[116:119], v5 offset:1024
    s_waitcnt lgkmcnt(9)
    v_mfma_f32_16x16x32_bf16 v[20:23], v[120:123], v[72:75], v[20:23]
    ds_read_b128 v[120:123], v5 offset:2048
    s_waitcnt lgkmcnt(9)
    v_mfma_f32_16x16x32_bf16 v[24:27], v[124:127], v[72:75], v[24:27]
    ds_read_b128 v[124:127], v5 offset:3072
    s_waitcnt lgkmcnt(9)
    v_mfma_f32_16x16x32_bf16 v[28:31], v[128:131], v[72:75], v[28:31]
    ds_read_b128 v[128:131], v5 offset:4096
    s_waitcnt vmcnt(10)
    buffer_load_dwordx2 v[108:109], v11, s[4:7], s52 offen offset:3072 sc1
    buffer_load_dwordx2 v[110:111], v11, s[4:7], s52 offen offset:3200 sc1
    s_waitcnt lgkmcnt(9)
    v_mfma_f32_16x16x32_bf16 v[12:15], v[132:135], v[76:79], v[12:15]
    ds_read_b128 v[132:135], v5 offset:5120
    s_waitcnt lgkmcnt(9)
    v_mfma_f32_16x16x32_bf16 v[16:19], v[136:139], v[76:79], v[16:19]
    ds_read_b128 v[136:139], v5 offset:6144
    s_waitcnt lgkmcnt(9)
    v_mfma_f32_16x16x32_bf16 v[20:23], v[140:143], v[76:79], v[20:23]
    ds_read_b128 v[140:143], v5 offset:7168
    s_waitcnt lgkmcnt(9)
    v_mfma_f32_16x16x32_bf16 v[24:27], v[144:147], v[76:79], v[24:27]
    ds_read_b128 v[144:147], v5 offset:8192
    s_waitcnt lgkmcnt(9)
    v_mfma_f32_16x16x32_bf16 v[28:31], v[148:151], v[76:79], v[28:31]
    ds_read_b128 v[148:151], v5 offset:9216
    s_waitcnt vmcnt(11)
    s_waitcnt lgkmcnt(9)
    v_mfma_f32_16x16x32_bf16 v[12:15], v[112:115], v[80:83], v[12:15]
    ds_read_b128 v[112:115], v5 offset:10240
    s_waitcnt lgkmcnt(9)
    v_mfma_f32_16x16x32_bf16 v[16:19], v[116:119], v[80:83], v[16:19]
    ds_read_b128 v[116:119], v5 offset:11264
    s_waitcnt lgkmcnt(9)
    v_mfma_f32_16x16x32_bf16 v[20:23], v[120:123], v[80:83], v[20:23]
    ds_read_b128 v[120:123], v5 offset:12288
    s_waitcnt lgkmcnt(9)
    v_mfma_f32_16x16x32_bf16 v[24:27], v[124:127], v[80:83], v[24:27]
    ds_read_b128 v[124:127], v5 offset:13312
    s_waitcnt lgkmcnt(9)
    v_mfma_f32_16x16x32_bf16 v[28:31], v[128:131], v[80:83], v[28:31]
    ds_read_b128 v[128:131], v5 offset:14336
    s_waitcnt vmcnt(10)
    s_waitcnt lgkmcnt(9)
    v_mfma_f32_16x16x32_bf16 v[12:15], v[132:135], v[84:87], v[12:15]
    ds_read_b128 v[132:135], v5 offset:15360
    s_waitcnt lgkmcnt(9)
    v_mfma_f32_16x16x32_bf16 v[16:19], v[136:139], v[84:87], v[16:19]
    ds_read_b128 v[136:139], v5 offset:16384
    s_waitcnt lgkmcnt(9)
    v_mfma_f32_16x16x32_bf16 v[20:23], v[140:143], v[84:87], v[20:23]
    ds_read_b128 v[140:143], v5 offset:17408
    s_waitcnt lgkmcnt(9)
    v_mfma_f32_16x16x32_bf16 v[24:27], v[144:147], v[84:87], v[24:27]
    ds_read_b128 v[144:147], v5 offset:18432
    s_waitcnt lgkmcnt(9)
    v_mfma_f32_16x16x32_bf16 v[28:31], v[148:151], v[84:87], v[28:31]
    ds_read_b128 v[148:151], v5 offset:19456
    s_waitcnt vmcnt(9)
    s_waitcnt lgkmcnt(9)
    v_mfma_f32_16x16x32_bf16 v[12:15], v[112:115], v[88:91], v[12:15]
    ds_read_b128 v[112:115], v5 offset:20480
    s_waitcnt lgkmcnt(9)
    v_mfma_f32_16x16x32_bf16 v[16:19], v[116:119], v[88:91], v[16:19]
    ds_read_b128 v[116:119], v5 offset:21504
    s_waitcnt lgkmcnt(9)
    v_mfma_f32_16x16x32_bf16 v[20:23], v[120:123], v[88:91], v[20:23]
    ds_read_b128 v[120:123], v5 offset:22528
    s_waitcnt lgkmcnt(9)
    v_mfma_f32_16x16x32_bf16 v[24:27], v[124:127], v[88:91], v[24:27]
    ds_read_b128 v[124:127], v5 offset:23552
    s_waitcnt lgkmcnt(9)
    v_mfma_f32_16x16x32_bf16 v[28:31], v[128:131], v[88:91], v[28:31]
    ds_read_b128 v[128:131], v5 offset:24576
    s_waitcnt vmcnt(8)
    s_waitcnt lgkmcnt(9)
    v_mfma_f32_16x16x32_bf16 v[12:15], v[132:135], v[92:95], v[12:15]
    ds_read_b128 v[132:135], v5 offset:25600
    s_waitcnt lgkmcnt(9)
    v_mfma_f32_16x16x32_bf16 v[16:19], v[136:139], v[92:95], v[16:19]
    ds_read_b128 v[136:139], v5 offset:26624
    s_waitcnt lgkmcnt(9)
    v_mfma_f32_16x16x32_bf16 v[20:23], v[140:143], v[92:95], v[20:23]
    ds_read_b128 v[140:143], v5 offset:27648
    s_waitcnt lgkmcnt(9)
    v_mfma_f32_16x16x32_bf16 v[24:27], v[144:147], v[92:95], v[24:27]
    ds_read_b128 v[144:147], v5 offset:28672
    s_waitcnt lgkmcnt(9)
    v_mfma_f32_16x16x32_bf16 v[28:31], v[148:151], v[92:95], v[28:31]
    ds_read_b128 v[148:151], v5 offset:29696
    s_waitcnt vmcnt(6)
    s_waitcnt lgkmcnt(9)
    v_mfma_f32_16x16x32_bf16 v[12:15], v[112:115], v[96:99], v[12:15]
    ds_read_b128 v[112:115], v5 offset:30720
    s_waitcnt lgkmcnt(9)
    v_mfma_f32_16x16x32_bf16 v[16:19], v[116:119], v[96:99], v[16:19]
    ds_read_b128 v[116:119], v5 offset:31744
    s_waitcnt lgkmcnt(9)
    v_mfma_f32_16x16x32_bf16 v[20:23], v[120:123], v[96:99], v[20:23]
    ds_read_b128 v[120:123], v5 offset:32768
    s_waitcnt lgkmcnt(9)
    v_mfma_f32_16x16x32_bf16 v[24:27], v[124:127], v[96:99], v[24:27]
    ds_read_b128 v[124:127], v5 offset:33792
    s_waitcnt lgkmcnt(9)
    v_mfma_f32_16x16x32_bf16 v[28:31], v[128:131], v[96:99], v[28:31]
    ds_read_b128 v[128:131], v5 offset:34816
    s_waitcnt vmcnt(4)
    s_waitcnt lgkmcnt(9)
    v_mfma_f32_16x16x32_bf16 v[12:15], v[132:135], v[100:103], v[12:15]
    ds_read_b128 v[132:135], v5 offset:35840
    s_waitcnt lgkmcnt(9)
    v_mfma_f32_16x16x32_bf16 v[16:19], v[136:139], v[100:103], v[16:19]
    ds_read_b128 v[136:139], v5 offset:36864
    s_waitcnt lgkmcnt(9)
    v_mfma_f32_16x16x32_bf16 v[20:23], v[140:143], v[100:103], v[20:23]
    ds_read_b128 v[140:143], v5 offset:37888
    s_waitcnt lgkmcnt(9)
    v_mfma_f32_16x16x32_bf16 v[24:27], v[144:147], v[100:103], v[24:27]
    ds_read_b128 v[144:147], v5 offset:38912
    s_waitcnt lgkmcnt(9)
    v_mfma_f32_16x16x32_bf16 v[28:31], v[148:151], v[100:103], v[28:31]
    ds_read_b128 v[148:151], v5 offset:39936
    s_waitcnt vmcnt(2)
    s_waitcnt lgkmcnt(9)
    v_mfma_f32_16x16x32_bf16 v[12:15], v[112:115], v[104:107], v[12:15]
    s_waitcnt lgkmcnt(8)
    v_mfma_f32_16x16x32_bf16 v[16:19], v[116:119], v[104:107], v[16:19]
    s_waitcnt lgkmcnt(7)
    v_mfma_f32_16x16x32_bf16 v[20:23], v[120:123], v[104:107], v[20:23]
    s_waitcnt lgkmcnt(6)
    v_mfma_f32_16x16x32_bf16 v[24:27], v[124:127], v[104:107], v[24:27]
    s_waitcnt lgkmcnt(5)
    v_mfma_f32_16x16x32_bf16 v[28:31], v[128:131], v[104:107], v[28:31]
    s_waitcnt vmcnt(0)
    s_waitcnt lgkmcnt(4)
    v_mfma_f32_16x16x32_bf16 v[12:15], v[132:135], v[108:111], v[12:15]
    s_waitcnt lgkmcnt(3)
    v_mfma_f32_16x16x32_bf16 v[16:19], v[136:139], v[108:111], v[16:19]
    s_waitcnt lgkmcnt(2)
    v_mfma_f32_16x16x32_bf16 v[20:23], v[140:143], v[108:111], v[20:23]
    s_waitcnt lgkmcnt(1)
    v_mfma_f32_16x16x32_bf16 v[24:27], v[144:147], v[108:111], v[24:27]
    s_waitcnt lgkmcnt(0)
    v_mfma_f32_16x16x32_bf16 v[28:31], v[148:151], v[108:111], v[28:31]
    v_lshlrev_b32 v10, 3, v1
    s_nop 2
    v_cvt_pk_bf16_f32 v152, v12, v13
    v_cvt_pk_bf16_f32 v153, v14, v15
    v_cvt_pk_bf16_f32 v154, v16, v17
    v_cvt_pk_bf16_f32 v155, v18, v19
    v_cvt_pk_bf16_f32 v156, v20, v21
    v_cvt_pk_bf16_f32 v157, v22, v23
    v_cvt_pk_bf16_f32 v158, v24, v25
    v_cvt_pk_bf16_f32 v159, v26, v27
    v_cvt_pk_bf16_f32 v160, v28, v29
    v_cvt_pk_bf16_f32 v161, v30, v31
    s_cmp_eq_u32 s92, 3
    s_cbranch_scc0 L_g2_mid
    s_mov_b32 s12, s100
    s_mov_b32 s13, s101
    s_mov_b32 s14, 2621440
    s_mov_b32 s15, 0x20000
    buffer_store_dwordx4 v[152:155], v6, s[12:15], 0 offen
    buffer_store_dwordx4 v[156:159], v6, s[12:15], 0 offen offset:64
    buffer_store_dwordx2 v[160:161], v7, s[12:15], 0 offen
    s_branch L_fin
L_g2_mid:
    buffer_store_dwordx4 v[152:155], v8, s[4:7], 0 offen sc1
    buffer_store_dwordx4 v[156:159], v8, s[4:7], 0 offen offset:1024 sc1
    buffer_store_dwordx2 v[160:161], v9, s[4:7], 0 offen sc1
    v_mfma_f32_16x16x32_bf16 v[36:39], v[152:155], v[152:155], 0
    v_mfma_f32_16x16x32_bf16 v[32:35], v[164:167], v[152:155], 0
    v_mfma_f32_16x16x32_bf16 v[36:39], v[156:159], v[156:159], v[36:39]
    v_mfma_f32_16x16x32_bf16 v[32:35], v[164:167], v[156:159], v[32:35]
    v_mfma_f32_16x16x32_bf16 v[36:39], v[160:163], v[160:163], v[36:39]
    v_mfma_f32_16x16x32_bf16 v[32:35], v[164:167], v[160:163], v[32:35]
    s_mov_b32 exec_lo, 0x00f0000f
    s_mov_b32 exec_hi, 0xf0000f00
    s_nop 4
    v_cndmask_b32 v36, v36, v37, s[40:41]
    v_cndmask_b32 v36, v36, v38, s[42:43]
    v_cndmask_b32 v33, v36, v39, s[44:45]
    buffer_store_dwordx2 v[32:33], v10, s[4:7], s34 offen sc1
    s_mov_b64 exec, -1
    s_barrier
    s_lshl_b32 s60, s35, 7
    v_mul_u32_u24 v11, 139264, v0
    v_add_u32 v11, s60, v11
    v_mov_b32 v3, 1
    s_waitcnt vmcnt(0)
    s_mov_b64 exec, 1
    buffer_atomic_add v3, v11, s[4:7], 0 offen sc1
    s_mov_b64 exec, -1
L_g2_next:
    s_add_u32 s92, s92, 1
    s_cmp_eq_u32 s92, 2
    s_cbranch_scc1 L_g1a
L_g1b:
    s_cmp_lt_u32 s3, 8
    s_cbranch_scc1 L_g1b_comp
L_g1b_h:
    s_barrier
    s_waitcnt vmcnt(0)
    s_barrier
    s_and_b32 s25, s2, 1
    s_lshl_b32 s25, s25, 2
    s_lshr_b32 s30, s2, 6
    s_add_u32 s25, s25, s30
    s_add_u32 s26, s25, 1032
    s_lshl_b32 s60, s26, 7
    s_add_u32 s58, s4, s60
    s_addc_u32 s59, s5, 0
    s_mov_b32 s61, 0
L_g1b_t2_pp:
    s_mov_b32 s16, 0
    s_atomic_add s16, s[58:59], 0 glc
    s_add_u32 s61, s61, 1
    s_waitcnt lgkmcnt(0)
    s_cmp_ge_u32 s16, 20
    s_cbranch_scc1 L_g1b_t2_pp_ok
    s_cmp_lt_u32 s61, 200000
    s_cbranch_scc1 L_g1b_t2_pp
L_g1b_t2_pp_ok:
    s_sub_u32 s28, s3, 8
    s_mul_i32 s28, s28, 35840
    s_mul_i32 s24, s25, 102400
    s_add_u32 s24, s24, s28
    s_add_u32 s24, s24, 6952960
    s_add_u32 m0, s28, 81920
    s_bfe_u32 s28, s2, 0x30003
    s_mul_i32 s28, s28, 4480
    s_add_u32 s24, s24, s28
    v_lshlrev_b32 v6, 7, v0
    buffer_load_dword v7, v6, s[4:7], s24 offen
    s_add_u32 s24, s24, 8192
    s_cmp_eq_u32 s92, 1
    s_cbranch_scc0 L_g1b_nt
    s_and_b32 s25, s2, 1
    s_lshl_b32 s25, s25, 3
    s_lshr_b32 s30, s2, 5
    s_add_u32 s25, s25, s30
    s_add_u32 s26, s25, 1040
    s_lshl_b32 s60, s26, 7
    s_add_u32 s58, s4, s60
    s_addc_u32 s59, s5, 0
    s_mov_b32 s61, 0
L_g1b_pq:
    s_mov_b32 s16, 0
    s_atomic_add s16, s[58:59], 0 glc
    s_add_u32 s61, s61, 1
    s_waitcnt lgkmcnt(0)
    s_cmp_ge_u32 s16, 8
    s_cbranch_scc1 L_g1b_pq_ok
    s_cmp_lt_u32 s61, 200000
    s_cbranch_scc1 L_g1b_pq
L_g1b_pq_ok:
    s_sub_u32 s28, s3, 8
    s_mul_i32 s28, s28, 16384
    s_mul_i32 s24, s25, 163840
    s_add_u32 s24, s24, s28
    s_bfe_u32 s28, s2, 0x20003
    s_mul_i32 s28, s28, 40960
    s_add_u32 s24, s24, s28
    s_add_u32 s24, s24, 860160
    v_lshlrev_b32 v6, 7, v0
L_g1b_nt:
    s_barrier
    s_and_b32 s25, s2, 1
    s_lshl_b32 s25, s25, 2
    s_lshr_b32 s30, s2, 6
    s_add_u32 s25, s25, s30
    s_sub_u32 s28, s3, 8
    s_mul_i32 s28, s28, 15360
    s_mul_i32 s24, s25, 102400
    s_add_u32 s24, s24, s28
    s_add_u32 s24, s24, 6922240
    s_add_u32 m0, s28, 51200
    s_mov_b32 s23, 5
L_g1b_w2a:
    buffer_load_dwordx4 v1, s[4:7], s24 offen offset:0 sc1 lds
    buffer_load_dwordx4 v1, s[4:7], s24 offen offset:1024 sc1 lds
    buffer_load_dwordx4 v1, s[4:7], s24 offen offset:2048 sc1 lds
    s_add_u32 m0, m0, 3072
    s_add_u32 s24, s24, 3072
    s_sub_u32 s23, s23, 1
    s_cmp_lg_u32 s23, 0
    s_cbranch_scc1 L_g1b_w2a
    s_barrier
    s_and_b32 s25, s2, 1
    s_lshl_b32 s25, s25, 2
    s_lshr_b32 s30, s2, 6
    s_add_u32 s25, s25, s30
    s_sub_u32 s28, s3, 8
    s_mul_i32 s28, s28, 35840
    s_mul_i32 s24, s25, 102400
    s_add_u32 s24, s24, s28
    s_add_u32 s24, s24, 6952960
    s_add_u32 m0, s28, 81920
    s_mov_b32 s23, 5
L_g1b_w2b:
    buffer_load_dwordx4 v1, s[4:7], s24 offen offset:0 sc1 lds
    buffer_load_dwordx4 v1, s[4:7], s24 offen offset:1024 sc1 lds
    buffer_load_dwordx4 v1, s[4:7], s24 offen offset:2048 sc1 lds
    buffer_load_dwordx4 v1, s[4:7], s24 offen offset:3072 sc1 lds
    s_add_u32 m0, m0, 4096
    s_add_u32 s24, s24, 4096
    buffer_load_dwordx4 v1, s[4:7], s24 offen offset:0 sc1 lds
    buffer_load_dwordx4 v1, s[4:7], s24 offen offset:1024 sc1 lds
    buffer_load_dwordx4 v1, s[4:7], s24 offen offset:2048 sc1 lds
    s_add_u32 m0, m0, 3072
    s_add_u32 s24, s24, 3072
    s_sub_u32 s23, s23, 1
    s_cmp_lg_u32 s23, 0
    s_cbranch_scc1 L_g1b_w2b
    s_branch L_g2
L_g1b_comp:
    s_bfe_u32 s20, s2, 0x20001
    s_lshl_b32 s20, s20, 2
    s_bfe_u32 s28, s2, 0x20003
    s_add_u32 s20, s20, s28
    s_and_b32 s21, s2, 1
    s_lshl_b32 s21, s21, 3
    s_lshr_b32 s28, s2, 5
    s_add_u32 s21, s21, s28
    v_and_b32 v1, 15, v0
    v_lshrrev_b32 v2, 4, v0
    s_and_b32 s33, s3, 3
    s_lshr_b32 s30, s3, 2
    s_mov_b32 s31, 352
    s_lshl_b32 s28, s33, 4
    s_sub_u32 s28, s28, 8
    v_add_u32 v11, s28, v1
    v_add_u32 v12, 16, v11
    v_max_i32 v11, 0, v11
    v_min_u32 v13, 2, v2
    v_lshlrev_b32 v13, 4, v13
    v_mad_u32_u24 v13, s30, 48, v13
    v_mad_u32_u24 v18, v11, s31, v13
    v_mad_u32_u24 v7, v12, s31, v13
    v_lshrrev_b32 v11, 2, v0
    v_add_u32 v11, s28, v11
    v_add_u32 v12, 16, v11
    v_max_i32 v11, 0, v11
    v_and_b32 v13, 3, v0
    v_lshlrev_b32 v13, 3, v13
    v_mad_u32_u24 v13, s30, 64, v13
    v_mad_u32_u24 v20, v11, s31, v13
    v_mad_u32_u24 v19, v12, s31, v13
    v_lshrrev_b32 v11, 3, v1
    v_mul_u32_u24 v21, 20480, v11
    v_and_b32 v11, 7, v1
    v_and_b32 v12, 1, v2
    v_lshl_or_b32 v11, v11, 1, v12
    v_lshl_add_u32 v22, v11, 4, v21
    v_lshl_add_u32 v21, v11, 3, v21
    v_lshrrev_b32 v11, 1, v2
    v_lshl_add_u32 v22, v11, 8, v22
    v_lshlrev_b32 v12, 2, v2
    v_sub_u32 v12, v1, v12
    s_or_b32 s28, s20, s33
    s_cmp_eq_u32 s28, 0
    s_cselect_b32 s28, -64, -9
    v_subrev_u32 v11, 0, v12
    v_cmp_gt_u32 s[8:9], 8, v11
    v_cmp_ge_i32 s[48:49], s28, v11
    v_subrev_u32 v11, 1, v12
    v_cmp_gt_u32 s[10:11], 8, v11
    v_cmp_ge_i32 s[50:51], s28, v11
    v_subrev_u32 v11, 2, v12
    v_cmp_gt_u32 s[12:13], 8, v11
    v_cmp_ge_i32 s[52:53], s28, v11
    v_subrev_u32 v11, 3, v12
    v_cmp_gt_u32 s[14:15], 8, v11
    v_cmp_ge_i32 s[54:55], s28, v11
    s_lshl_b32 s34, s92, 4
    s_add_u32 s34, s34, s20
    s_lshl_b32 s34, s34, 2
    s_add_u32 s34, s34, s33
    s_mul_i32 s35, s34, 40960
    s_lshl_b32 s34, s34, 1
    s_add_u32 s34, s34, s30
    s_add_u32 s34, s34, 64
    s_add_u32 s35, s35, 23470080
    s_lshl_b32 s28, s21, 1
    s_add_u32 s28, s28, s30
    s_lshl_b32 s31, s28, 7
    s_add_u32 s31, s31, s35
    s_add_u32 s31, s31, 16384
    s_lshl_b32 s28, s28, 9
    s_add_u32 s35, s35, s28
    s_sub_u32 s40, s92, 1
    s_lshl_b32 s33, s40, 17
    s_add_u32 s33, s33, 139264
    s_mul_i32 s41, s40, 2621440
    s_add_u32 s41, s41, 33955840
    s_lshr_b32 s28, s21, 2
    s_mul_i32 s29, s28, 40960
    s_and_b32 s28, s21, 3
    s_mul_i32 s28, s28, 5120
    s_add_u32 s29, s29, s28
    s_add_u32 s29, s29, 696320
    v_lshlrev_b32 v11, 3, v1
    v_lshl_add_u32 v11, v2, 8, v11
    v_lshlrev_b32 v3, 4, v0
    v_add_u32 v4, 20480, v3
    s_lshl_b32 s36, s20, 3
    s_cmp_ge_u32 s3, 4
    s_cbranch_scc1 L_g1b_halo
    s_lshl_b32 s28, s3, 1
    s_add_u32 s36, s36, s28
    s_mul_i32 s38, s36, 20480
    s_add_u32 s38, s38, s41
    v_add_u32 v5, 122880, v3
    s_lshl_b32 s28, s40, 7
    s_add_u32 s28, s28, s36
    s_add_u32 s28, s28, 576
    v_add_u32 v16, s28, v0
    s_lshl_b32 s28, s36, 10
    s_add_u32 s33, s33, s28
    v_cmp_gt_u32 vcc, 2, v2
    v_mov_b32 v14, 0x3ea52b5c
    v_cndmask_b32 v14, 1.0, v14, vcc
    s_mul_i32 s28, s3, 5632
    s_add_u32 s28, s28, 2816
    v_and_b32 v13, 1, v1
    v_mul_u32_u24 v12, 25360, v13
    v_lshrrev_b32 v13, 1, v1
    v_mul_u32_u24 v13, 352, v13
    v_add3_u32 v12, v12, v13, s28
    v_mad_u32_u24 v6, v2, 48, v12
    v_add_u32 v13, 0, v2
    v_cmp_le_u32 vcc, 5, v13
    v_cmp_eq_u32 s[24:25], 10, v13
    v_lshl_add_u32 v8, v13, 3, v12
    v_cmp_eq_u32 s[26:27], 11, v13
    v_cndmask_b32 v13, 0, 24, vcc
    v_cndmask_b32 v13, v13, -8, s[24:25]
    v_cndmask_b32 v13, v13, 48, s[26:27]
    v_add3_u32 v8, v8, v13, 0
    v_subrev_u32 v13, 32, v8
    v_cndmask_b32 v8, v8, v13, s[24:25]
    v_cndmask_b32 v8, v8, v13, s[26:27]
    v_add_u32 v13, 4, v2
    v_cmp_le_u32 vcc, 5, v13
    v_cmp_eq_u32 s[24:25], 10, v13
    v_lshl_add_u32 v9, v13, 3, v12
    v_cmp_eq_u32 s[26:27], 11, v13
    v_cndmask_b32 v13, 0, 24, vcc
    v_cndmask_b32 v13, v13, -8, s[24:25]
    v_cndmask_b32 v13, v13, 48, s[26:27]
    v_add3_u32 v9, v9, v13, 0
    v_subrev_u32 v13, 32, v9
    v_cndmask_b32 v9, v9, v13, s[24:25]
    v_cndmask_b32 v9, v9, v13, s[26:27]
    v_add_u32 v13, 8, v2
    v_cmp_le_u32 vcc, 5, v13
    v_cmp_eq_u32 s[24:25], 10, v13
    v_lshl_add_u32 v10, v13, 3, v12
    v_cmp_eq_u32 s[26:27], 11, v13
    v_cndmask_b32 v13, 0, 24, vcc
    v_cndmask_b32 v13, v13, -8, s[24:25]
    v_cndmask_b32 v13, v13, 48, s[26:27]
    v_add3_u32 v10, v10, v13, 0
    v_subrev_u32 v13, 32, v10
    v_cndmask_b32 v10, v10, v13, s[24:25]
    v_cndmask_b32 v10, v10, v13, s[26:27]
    s_cmp_eq_u32 s3, 0
    s_cselect_b32 s30, 3, 2
    s_cmp_eq_u32 s36, 0
    s_cselect_b32 s30, 2, s30
    v_cmp_eq_u32 vcc, 2, v0
    v_subrev_u32 v17, s30, v16
    s_nop 0
    v_cndmask_b32 v16, v16, v17, vcc
    v_lshlrev_b32 v16, 7, v16
    s_lshl_b32 s28, s40, 7
    s_add_u32 s28, s28, s36
    s_add_u32 s28, s28, 576
    s_add_u32 s43, s28, 2
    s_sub_u32 s43, s43, s30
    s_cmp_eq_u32 s30, 3
    s_cbranch_scc0 L_g1b_p2
    s_lshl_b32 s60, s28, 7
    s_add_u32 s58, s4, s60
    s_addc_u32 s59, s5, 0
    s_mov_b32 s61, 0
    s_lshl_b32 s60, s43, 7
L_g1b_poll3:
    s_mov_b32 s16, 0
    s_mov_b32 s17, 0
    s_mov_b32 s18, 0
    s_atomic_add s16, s[58:59], 0 glc
    s_atomic_add s17, s[58:59], 128 glc
    s_atomic_add s18, s[4:5], s60 glc
    s_add_u32 s61, s61, 1
    s_waitcnt lgkmcnt(0)
    s_min_u32 s16, s16, s17
    s_min_u32 s16, s16, s18
    s_cmp_ge_u32 s16, 8
    s_cbranch_scc1 L_g1b_poll3_ok
    s_cmp_lt_u32 s61, 200000
    s_cbranch_scc1 L_g1b_poll3
L_g1b_poll3_ok:
    s_branch L_g1b_poll_ok
L_g1b_p2:
    s_lshl_b32 s60, s28, 7
    s_add_u32 s58, s4, s60
    s_addc_u32 s59, s5, 0
    s_mov_b32 s61, 0
L_g1b_poll:
    s_mov_b32 s16, 0
    s_mov_b32 s17, 0
    s_atomic_add s16, s[58:59], 0 glc
    s_atomic_add s17, s[58:59], 128 glc
    s_add_u32 s61, s61, 1
    s_waitcnt lgkmcnt(0)
    s_min_u32 s16, s16, s17
    s_cmp_ge_u32 s16, 8
    s_cbranch_scc1 L_g1b_poll_ok
    s_cmp_lt_u32 s61, 200000
    s_cbranch_scc1 L_g1b_poll
L_g1b_poll_ok:
    buffer_load_dwordx2 v[24:25], v11, s[4:7], s33 offen offset:0 sc1
    buffer_load_dwordx2 v[26:27], v11, s[4:7], s33 offen offset:128 sc1
    buffer_load_dwordx2 v[28:29], v11, s[4:7], s33 offen offset:1024 sc1
    buffer_load_dwordx2 v[30:31], v11, s[4:7], s33 offen offset:1152 sc1
    buffer_load_dwordx4 v[128:131], v3, s[4:7], s38 offen offset:0 sc1
    buffer_load_dwordx4 v[132:135], v4, s[4:7], s38 offen offset:0 sc1
    buffer_load_dwordx4 v[136:139], v3, s[4:7], s38 offen offset:1024 sc1
    buffer_load_dwordx4 v[140:143], v4, s[4:7], s38 offen offset:1024 sc1
    buffer_load_dwordx4 v[144:147], v3, s[4:7], s38 offen offset:2048 sc1
    buffer_load_dwordx4 v[148:151], v4, s[4:7], s38 offen offset:2048 sc1
    buffer_load_dwordx4 v[152:155], v3, s[4:7], s38 offen offset:3072 sc1
    buffer_load_dwordx4 v[156:159], v4, s[4:7], s38 offen offset:3072 sc1
    s_add_u32 s38, s38, 4096
    s_add_u32 s39, s38, 1024
    s_mov_b32 s23, 0
    s_mov_b32 s47, 4294844416
    s_barrier
    ds_read_b128 v[96:99], v5 offset:0
    ds_read_b128 v[100:103], v5 offset:1024
    ds_read_b128 v[104:107], v5 offset:2048
    ds_read_b128 v[108:111], v5 offset:3072
    ds_read_b128 v[112:115], v5 offset:4096
    ds_read_b128 v[116:119], v5 offset:5120
    ds_read_b128 v[120:123], v5 offset:6144
    s_waitcnt vmcnt(6)
    s_waitcnt lgkmcnt(6)
    v_mfma_f32_16x16x32_bf16 v[32:35], v[96:99], v[128:131], 0
    ds_read_b128 v[124:127], v5 offset:7168
    v_mfma_f32_16x16x32_bf16 v[64:67], v[96:99], v[132:135], 0
    v_pk_add_f32 v[24:25], v[24:25], v[26:27]
    v_pk_add_f32 v[28:29], v[28:29], v[30:31]
    s_waitcnt lgkmcnt(6)
    v_mfma_f32_16x16x32_bf16 v[36:39], v[100:103], v[128:131], 0
    ds_read_b128 v[96:99], v5 offset:8192
    v_mfma_f32_16x16x32_bf16 v[68:71], v[100:103], v[132:135], 0
    buffer_load_dwordx4 v[160:163], v3, s[4:7], s38 offen offset:0 sc1
    s_waitcnt lgkmcnt(6)
    v_mfma_f32_16x16x32_bf16 v[40:43], v[104:107], v[128:131], 0
    ds_read_b128 v[100:103], v5 offset:9216
    v_mfma_f32_16x16x32_bf16 v[72:75], v[104:107], v[132:135], 0
    v_mov_b32 v26, v24
    v_mov_b32 v27, v25
    s_waitcnt lgkmcnt(6)
    v_mfma_f32_16x16x32_bf16 v[44:47], v[108:111], v[128:131], 0
    ds_read_b128 v[104:107], v5 offset:10240
    v_mfma_f32_16x16x32_bf16 v[76:79], v[108:111], v[132:135], 0
    v_mov_b32 v30, v28
    v_mov_b32 v31, v29
    s_waitcnt lgkmcnt(6)
    v_mfma_f32_16x16x32_bf16 v[48:51], v[112:115], v[128:131], 0
    ds_read_b128 v[108:111], v5 offset:11264
    v_mfma_f32_16x16x32_bf16 v[80:83], v[112:115], v[132:135], 0
    v_permlane32_swap_b32 v24, v26
    v_permlane32_swap_b32 v25, v27
    s_waitcnt lgkmcnt(6)
    v_mfma_f32_16x16x32_bf16 v[52:55], v[116:119], v[128:131], 0
    ds_read_b128 v[112:115], v5 offset:12288
    v_mfma_f32_16x16x32_bf16 v[84:87], v[116:119], v[132:135], 0
    buffer_load_dwordx4 v[164:167], v4, s[4:7], s38 offen offset:0 sc1
    s_waitcnt lgkmcnt(6)
    v_mfma_f32_16x16x32_bf16 v[56:59], v[120:123], v[128:131], 0
    ds_read_b128 v[116:119], v5 offset:13312
    v_mfma_f32_16x16x32_bf16 v[88:91], v[120:123], v[132:135], 0
    v_permlane32_swap_b32 v28, v30
    v_permlane32_swap_b32 v29, v31
    s_waitcnt lgkmcnt(6)
    v_mfma_f32_16x16x32_bf16 v[60:63], v[124:127], v[128:131], 0
    ds_read_b128 v[120:123], v5 offset:14336
    v_mfma_f32_16x16x32_bf16 v[92:95], v[124:127], v[132:135], 0
    v_add_f32 v24, v24, v26
    v_add_f32 v25, v25, v27
    s_waitcnt vmcnt(6)
    s_waitcnt lgkmcnt(6)
    v_mfma_f32_16x16x32_bf16 v[32:35], v[96:99], v[136:139], v[32:35]
    ds_read_b128 v[124:127], v5 offset:15360
    v_mfma_f32_16x16x32_bf16 v[64:67], v[96:99], v[140:143], v[64:67]
    v_add_f32 v28, v28, v30
    v_add_f32 v29, v29, v31
    s_waitcnt lgkmcnt(6)
    v_mfma_f32_16x16x32_bf16 v[36:39], v[100:103], v[136:139], v[36:39]
    ds_read_b128 v[96:99], v5 offset:16384
    v_mfma_f32_16x16x32_bf16 v[68:71], v[100:103], v[140:143], v[68:71]
    buffer_load_dwordx4 v[128:131], v3, s[4:7], s39 offen offset:0 sc1
    s_waitcnt lgkmcnt(6)
    v_mfma_f32_16x16x32_bf16 v[40:43], v[104:107], v[136:139], v[40:43]
    ds_read_b128 v[100:103], v5 offset:17408
    v_mfma_f32_16x16x32_bf16 v[72:75], v[104:107], v[140:143], v[72:75]
    v_mov_b32 v26, v24
    v_mov_b32 v27, v25
    s_waitcnt lgkmcnt(6)
    v_mfma_f32_16x16x32_bf16 v[44:47], v[108:111], v[136:139], v[44:47]
    ds_read_b128 v[104:107], v5 offset:18432
    v_mfma_f32_16x16x32_bf16 v[76:79], v[108:111], v[140:143], v[76:79]
    v_mov_b32 v30, v28
    v_mov_b32 v31, v29
    s_waitcnt lgkmcnt(6)
    v_mfma_f32_16x16x32_bf16 v[48:51], v[112:115], v[136:139], v[48:51]
    ds_read_b128 v[108:111], v5 offset:19456
    v_mfma_f32_16x16x32_bf16 v[80:83], v[112:115], v[140:143], v[80:83]
    v_permlane16_swap_b32 v24, v26
    v_permlane16_swap_b32 v25, v27
    s_waitcnt lgkmcnt(6)
    v_mfma_f32_16x16x32_bf16 v[52:55], v[116:119], v[136:139], v[52:55]
    ds_read_b128 v[112:115], v5 offset:20480
    v_mfma_f32_16x16x32_bf16 v[84:87], v[116:119], v[140:143], v[84:87]
    buffer_load_dwordx4 v[132:135], v4, s[4:7], s39 offen offset:0 sc1
    s_waitcnt lgkmcnt(6)
    v_mfma_f32_16x16x32_bf16 v[56:59], v[120:123], v[136:139], v[56:59]
    ds_read_b128 v[116:119], v5 offset:21504
    v_mfma_f32_16x16x32_bf16 v[88:91], v[120:123], v[140:143], v[88:91]
    v_permlane16_swap_b32 v28, v30
    v_permlane16_swap_b32 v29, v31
    s_waitcnt lgkmcnt(6)
    v_mfma_f32_16x16x32_bf16 v[60:63], v[124:127], v[136:139], v[60:63]
    ds_read_b128 v[120:123], v5 offset:22528
    v_mfma_f32_16x16x32_bf16 v[92:95], v[124:127], v[140:143], v[92:95]
    v_add_f32 v24, v24, v26
    v_add_f32 v25, v25, v27
    s_waitcnt vmcnt(6)
    s_waitcnt lgkmcnt(6)
    v_mfma_f32_16x16x32_bf16 v[32:35], v[96:99], v[144:147], v[32:35]
    ds_read_b128 v[124:127], v5 offset:23552
    v_mfma_f32_16x16x32_bf16 v[64:67], v[96:99], v[148:151], v[64:67]
    v_add_f32 v28, v28, v30
    v_add_f32 v29, v29, v31
    s_waitcnt lgkmcnt(6)
    v_mfma_f32_16x16x32_bf16 v[36:39], v[100:103], v[144:147], v[36:39]
    ds_read_b128 v[96:99], v5 offset:24576
    v_mfma_f32_16x16x32_bf16 v[68:71], v[100:103], v[148:151], v[68:71]
    buffer_load_dwordx4 v[136:139], v3, s[4:7], s39 offen offset:1024 sc1
    s_waitcnt lgkmcnt(6)
    v_mfma_f32_16x16x32_bf16 v[40:43], v[104:107], v[144:147], v[40:43]
    ds_read_b128 v[100:103], v5 offset:25600
    v_mfma_f32_16x16x32_bf16 v[72:75], v[104:107], v[148:151], v[72:75]
    v_mul_f32 v24, 0x3acccccd, v24
    v_mul_f32 v25, 0x3acccccd, v25
    s_waitcnt lgkmcnt(6)
    v_mfma_f32_16x16x32_bf16 v[44:47], v[108:111], v[144:147], v[44:47]
    ds_read_b128 v[104:107], v5 offset:26624
    v_mfma_f32_16x16x32_bf16 v[76:79], v[108:111], v[148:151], v[76:79]
    v_fma_f32 v25, -v24, v24, v25
    v_max_f32 v25, 0, v25
    s_waitcnt lgkmcnt(6)
    v_mfma_f32_16x16x32_bf16 v[48:51], v[112:115], v[144:147], v[48:51]
    ds_read_b128 v[108:111], v5 offset:27648
    v_mfma_f32_16x16x32_bf16 v[80:83], v[112:115], v[148:151], v[80:83]
    v_add_f32 v25, 0x3727c5ac, v25
    v_rsq_f32 v25, v25
    s_waitcnt lgkmcnt(6)
    v_mfma_f32_16x16x32_bf16 v[52:55], v[116:119], v[144:147], v[52:55]
    ds_read_b128 v[112:115], v5 offset:28672
    v_mfma_f32_16x16x32_bf16 v[84:87], v[116:119], v[148:151], v[84:87]
    buffer_load_dwordx4 v[140:143], v4, s[4:7], s39 offen offset:1024 sc1
    s_waitcnt lgkmcnt(6)
    v_mfma_f32_16x16x32_bf16 v[56:59], v[120:123], v[144:147], v[56:59]
    ds_read_b128 v[116:119], v5 offset:29696
    v_mfma_f32_16x16x32_bf16 v[88:91], v[120:123], v[148:151], v[88:91]
    v_mul_f32 v28, 0x3acccccd, v28
    s_waitcnt lgkmcnt(6)
    v_mfma_f32_16x16x32_bf16 v[60:63], v[124:127], v[144:147], v[60:63]
    ds_read_b128 v[120:123], v5 offset:30720
    v_mfma_f32_16x16x32_bf16 v[92:95], v[124:127], v[148:151], v[92:95]
    v_mul_f32 v29, 0x3acccccd, v29
    s_waitcnt vmcnt(6)
    s_waitcnt lgkmcnt(6)
    v_mfma_f32_16x16x32_bf16 v[32:35], v[96:99], v[152:155], v[32:35]
    ds_read_b128 v[124:127], v5 offset:31744
    v_mfma_f32_16x16x32_bf16 v[64:67], v[96:99], v[156:159], v[64:67]
    v_fma_f32 v29, -v28, v28, v29
    s_waitcnt lgkmcnt(6)
    v_mfma_f32_16x16x32_bf16 v[36:39], v[100:103], v[152:155], v[36:39]
    ds_read_b128 v[96:99], v5 offset:32768
    v_mfma_f32_16x16x32_bf16 v[68:71], v[100:103], v[156:159], v[68:71]
    buffer_load_dwordx4 v[144:147], v3, s[4:7], s39 offen offset:2048 sc1
    s_waitcnt lgkmcnt(6)
    v_mfma_f32_16x16x32_bf16 v[40:43], v[104:107], v[152:155], v[40:43]
    ds_read_b128 v[100:103], v5 offset:33792
    v_mfma_f32_16x16x32_bf16 v[72:75], v[104:107], v[156:159], v[72:75]
    v_max_f32 v29, 0, v29
    s_waitcnt lgkmcnt(6)
    v_mfma_f32_16x16x32_bf16 v[44:47], v[108:111], v[152:155], v[44:47]
    ds_read_b128 v[104:107], v5 offset:34816
    v_mfma_f32_16x16x32_bf16 v[76:79], v[108:111], v[156:159], v[76:79]
    v_add_f32 v29, 0x3727c5ac, v29
    s_waitcnt lgkmcnt(6)
    v_mfma_f32_16x16x32_bf16 v[48:51], v[112:115], v[152:155], v[48:51]
    ds_read_b128 v[108:111], v5 offset:35840
    v_mfma_f32_16x16x32_bf16 v[80:83], v[112:115], v[156:159], v[80:83]
    v_rsq_f32 v29, v29
    s_waitcnt lgkmcnt(6)
    v_mfma_f32_16x16x32_bf16 v[52:55], v[116:119], v[152:155], v[52:55]
    ds_read_b128 v[112:115], v5 offset:36864
    v_mfma_f32_16x16x32_bf16 v[84:87], v[116:119], v[156:159], v[84:87]
    buffer_load_dwordx4 v[148:151], v4, s[4:7], s39 offen offset:2048 sc1
    s_waitcnt lgkmcnt(6)
    v_mfma_f32_16x16x32_bf16 v[56:59], v[120:123], v[152:155], v[56:59]
    ds_read_b128 v[116:119], v5 offset:37888
    v_mfma_f32_16x16x32_bf16 v[88:91], v[120:123], v[156:159], v[88:91]
    v_mul_f32 v26, v14, v25
    s_waitcnt lgkmcnt(6)
    v_mfma_f32_16x16x32_bf16 v[60:63], v[124:127], v[152:155], v[60:63]
    ds_read_b128 v[120:123], v5 offset:38912
    v_mfma_f32_16x16x32_bf16 v[92:95], v[124:127], v[156:159], v[92:95]
    v_mul_f32 v30, v14, v29
    s_waitcnt vmcnt(6)
    s_waitcnt lgkmcnt(6)
    v_mfma_f32_16x16x32_bf16 v[32:35], v[96:99], v[160:163], v[32:35]
    ds_read_b128 v[124:127], v5 offset:39936
    v_mfma_f32_16x16x32_bf16 v[64:67], v[96:99], v[164:167], v[64:67]
    v_add_u32 v5, s47, v5
    s_waitcnt lgkmcnt(6)
    v_mfma_f32_16x16x32_bf16 v[36:39], v[100:103], v[160:163], v[36:39]
    ds_read_b128 v[96:99], v5 offset:0
    v_mfma_f32_16x16x32_bf16 v[68:71], v[100:103], v[164:167], v[68:71]
    buffer_load_dwordx4 v[152:155], v3, s[4:7], s39 offen offset:3072 sc1
    s_waitcnt lgkmcnt(6)
    v_mfma_f32_16x16x32_bf16 v[40:43], v[104:107], v[160:163], v[40:43]
    ds_read_b128 v[100:103], v5 offset:1024
    v_mfma_f32_16x16x32_bf16 v[72:75], v[104:107], v[164:167], v[72:75]
    s_add_u32 s38, s38, 5120
    s_waitcnt lgkmcnt(6)
    v_mfma_f32_16x16x32_bf16 v[44:47], v[108:111], v[160:163], v[44:47]
    ds_read_b128 v[104:107], v5 offset:2048
    v_mfma_f32_16x16x32_bf16 v[76:79], v[108:111], v[164:167], v[76:79]
    s_add_u32 s23, s23, 1
    s_waitcnt lgkmcnt(6)
    v_mfma_f32_16x16x32_bf16 v[48:51], v[112:115], v[160:163], v[48:51]
    ds_read_b128 v[108:111], v5 offset:3072
    v_mfma_f32_16x16x32_bf16 v[80:83], v[112:115], v[164:167], v[80:83]
    s_waitcnt lgkmcnt(6)
    v_mfma_f32_16x16x32_bf16 v[52:55], v[116:119], v[160:163], v[52:55]
    ds_read_b128 v[112:115], v5 offset:4096
    v_mfma_f32_16x16x32_bf16 v[84:87], v[116:119], v[164:167], v[84:87]
    buffer_load_dwordx4 v[156:159], v4, s[4:7], s39 offen offset:3072 sc1
    s_waitcnt lgkmcnt(6)
    v_mfma_f32_16x16x32_bf16 v[56:59], v[120:123], v[160:163], v[56:59]
    ds_read_b128 v[116:119], v5 offset:5120
    v_mfma_f32_16x16x32_bf16 v[88:91], v[120:123], v[164:167], v[88:91]
    s_add_u32 s39, s38, 1024
    s_cmp_eq_u32 s23, 3
    s_cselect_b32 s39, s29, s39
    s_waitcnt lgkmcnt(6)
    v_mfma_f32_16x16x32_bf16 v[60:63], v[124:127], v[160:163], v[60:63]
    ds_read_b128 v[120:123], v5 offset:6144
    v_mfma_f32_16x16x32_bf16 v[92:95], v[124:127], v[164:167], v[92:95]
    s_cmp_eq_u32 s23, 3
    s_barrier
.p2align 4
L_g1b_loop:
    s_waitcnt vmcnt(6)
    s_waitcnt lgkmcnt(6)
    v_mfma_f32_16x16x32_bf16 v[32:35], v[96:99], v[128:131], v[32:35]
    ds_read_b128 v[124:127], v5 offset:7168
    v_mfma_f32_16x16x32_bf16 v[64:67], v[96:99], v[132:135], v[64:67]
    s_waitcnt lgkmcnt(6)
    v_mfma_f32_16x16x32_bf16 v[36:39], v[100:103], v[128:131], v[36:39]
    ds_read_b128 v[96:99], v5 offset:8192
    v_mfma_f32_16x16x32_bf16 v[68:71], v[100:103], v[132:135], v[68:71]
    buffer_load_dwordx4 v[160:163], v3, s[4:7], s38 offen offset:0 sc1
    s_waitcnt lgkmcnt(6)
    v_mfma_f32_16x16x32_bf16 v[40:43], v[104:107], v[128:131], v[40:43]
    ds_read_b128 v[100:103], v5 offset:9216
    v_mfma_f32_16x16x32_bf16 v[72:75], v[104:107], v[132:135], v[72:75]
    s_waitcnt lgkmcnt(6)
    v_mfma_f32_16x16x32_bf16 v[44:47], v[108:111], v[128:131], v[44:47]
    ds_read_b128 v[104:107], v5 offset:10240
    v_mfma_f32_16x16x32_bf16 v[76:79], v[108:111], v[132:135], v[76:79]
    s_waitcnt lgkmcnt(6)
    v_mfma_f32_16x16x32_bf16 v[48:51], v[112:115], v[128:131], v[48:51]
    ds_read_b128 v[108:111], v5 offset:11264
    v_mfma_f32_16x16x32_bf16 v[80:83], v[112:115], v[132:135], v[80:83]
    s_waitcnt lgkmcnt(6)
    v_mfma_f32_16x16x32_bf16 v[52:55], v[116:119], v[128:131], v[52:55]
    ds_read_b128 v[112:115], v5 offset:12288
    v_mfma_f32_16x16x32_bf16 v[84:87], v[116:119], v[132:135], v[84:87]
    buffer_load_dwordx4 v[164:167], v4, s[4:7], s38 offen offset:0 sc1
    s_waitcnt lgkmcnt(6)
    v_mfma_f32_16x16x32_bf16 v[56:59], v[120:123], v[128:131], v[56:59]
    ds_read_b128 v[116:119], v5 offset:13312
    v_mfma_f32_16x16x32_bf16 v[88:91], v[120:123], v[132:135], v[88:91]
    s_waitcnt lgkmcnt(6)
    v_mfma_f32_16x16x32_bf16 v[60:63], v[124:127], v[128:131], v[60:63]
    ds_read_b128 v[120:123], v5 offset:14336
    v_mfma_f32_16x16x32_bf16 v[92:95], v[124:127], v[132:135], v[92:95]
    s_waitcnt vmcnt(6)
    s_waitcnt lgkmcnt(6)
    v_mfma_f32_16x16x32_bf16 v[32:35], v[96:99], v[136:139], v[32:35]
    ds_read_b128 v[124:127], v5 offset:15360
    v_mfma_f32_16x16x32_bf16 v[64:67], v[96:99], v[140:143], v[64:67]
    s_waitcnt lgkmcnt(6)
    v_mfma_f32_16x16x32_bf16 v[36:39], v[100:103], v[136:139], v[36:39]
    ds_read_b128 v[96:99], v5 offset:16384
    v_mfma_f32_16x16x32_bf16 v[68:71], v[100:103], v[140:143], v[68:71]
    buffer_load_dwordx4 v[128:131], v3, s[4:7], s39 offen offset:0 sc1
    s_waitcnt lgkmcnt(6)
    v_mfma_f32_16x16x32_bf16 v[40:43], v[104:107], v[136:139], v[40:43]
    ds_read_b128 v[100:103], v5 offset:17408
    v_mfma_f32_16x16x32_bf16 v[72:75], v[104:107], v[140:143], v[72:75]
    s_waitcnt lgkmcnt(6)
    v_mfma_f32_16x16x32_bf16 v[44:47], v[108:111], v[136:139], v[44:47]
    ds_read_b128 v[104:107], v5 offset:18432
    v_mfma_f32_16x16x32_bf16 v[76:79], v[108:111], v[140:143], v[76:79]
    s_waitcnt lgkmcnt(6)
    v_mfma_f32_16x16x32_bf16 v[48:51], v[112:115], v[136:139], v[48:51]
    ds_read_b128 v[108:111], v5 offset:19456
    v_mfma_f32_16x16x32_bf16 v[80:83], v[112:115], v[140:143], v[80:83]
    s_waitcnt lgkmcnt(6)
    v_mfma_f32_16x16x32_bf16 v[52:55], v[116:119], v[136:139], v[52:55]
    ds_read_b128 v[112:115], v5 offset:20480
    v_mfma_f32_16x16x32_bf16 v[84:87], v[116:119], v[140:143], v[84:87]
    buffer_load_dwordx4 v[132:135], v4, s[4:7], s39 offen offset:0 sc1
    s_waitcnt lgkmcnt(6)
    v_mfma_f32_16x16x32_bf16 v[56:59], v[120:123], v[136:139], v[56:59]
    ds_read_b128 v[116:119], v5 offset:21504
    v_mfma_f32_16x16x32_bf16 v[88:91], v[120:123], v[140:143], v[88:91]
    s_waitcnt lgkmcnt(6)
    v_mfma_f32_16x16x32_bf16 v[60:63], v[124:127], v[136:139], v[60:63]
    ds_read_b128 v[120:123], v5 offset:22528
    v_mfma_f32_16x16x32_bf16 v[92:95], v[124:127], v[140:143], v[92:95]
    s_waitcnt vmcnt(6)
    s_waitcnt lgkmcnt(6)
    v_mfma_f32_16x16x32_bf16 v[32:35], v[96:99], v[144:147], v[32:35]
    ds_read_b128 v[124:127], v5 offset:23552
    v_mfma_f32_16x16x32_bf16 v[64:67], v[96:99], v[148:151], v[64:67]
    s_waitcnt lgkmcnt(6)
    v_mfma_f32_16x16x32_bf16 v[36:39], v[100:103], v[144:147], v[36:39]
    ds_read_b128 v[96:99], v5 offset:24576
    v_mfma_f32_16x16x32_bf16 v[68:71], v[100:103], v[148:151], v[68:71]
    buffer_load_dwordx4 v[136:139], v3, s[4:7], s39 offen offset:1024 sc1
    s_waitcnt lgkmcnt(6)
    v_mfma_f32_16x16x32_bf16 v[40:43], v[104:107], v[144:147], v[40:43]
    ds_read_b128 v[100:103], v5 offset:25600
    v_mfma_f32_16x16x32_bf16 v[72:75], v[104:107], v[148:151], v[72:75]
    s_waitcnt lgkmcnt(6)
    v_mfma_f32_16x16x32_bf16 v[44:47], v[108:111], v[144:147], v[44:47]
    ds_read_b128 v[104:107], v5 offset:26624
    v_mfma_f32_16x16x32_bf16 v[76:79], v[108:111], v[148:151], v[76:79]
    s_waitcnt lgkmcnt(6)
    v_mfma_f32_16x16x32_bf16 v[48:51], v[112:115], v[144:147], v[48:51]
    ds_read_b128 v[108:111], v5 offset:27648
    v_mfma_f32_16x16x32_bf16 v[80:83], v[112:115], v[148:151], v[80:83]
    s_waitcnt lgkmcnt(6)
    v_mfma_f32_16x16x32_bf16 v[52:55], v[116:119], v[144:147], v[52:55]
    ds_read_b128 v[112:115], v5 offset:28672
    v_mfma_f32_16x16x32_bf16 v[84:87], v[116:119], v[148:151], v[84:87]
    buffer_load_dwordx4 v[140:143], v4, s[4:7], s39 offen offset:1024 sc1
    s_waitcnt lgkmcnt(6)
    v_mfma_f32_16x16x32_bf16 v[56:59], v[120:123], v[144:147], v[56:59]
    ds_read_b128 v[116:119], v5 offset:29696
    v_mfma_f32_16x16x32_bf16 v[88:91], v[120:123], v[148:151], v[88:91]
    s_waitcnt lgkmcnt(6)
    v_mfma_f32_16x16x32_bf16 v[60:63], v[124:127], v[144:147], v[60:63]
    ds_read_b128 v[120:123], v5 offset:30720
    v_mfma_f32_16x16x32_bf16 v[92:95], v[124:127], v[148:151], v[92:95]
    s_waitcnt vmcnt(6)
    s_waitcnt lgkmcnt(6)
    v_mfma_f32_16x16x32_bf16 v[32:35], v[96:99], v[152:155], v[32:35]
    ds_read_b128 v[124:127], v5 offset:31744
    v_mfma_f32_16x16x32_bf16 v[64:67], v[96:99], v[156:159], v[64:67]
    s_waitcnt lgkmcnt(6)
    v_mfma_f32_16x16x32_bf16 v[36:39], v[100:103], v[152:155], v[36:39]
    ds_read_b128 v[96:99], v5 offset:32768
    v_mfma_f32_16x16x32_bf16 v[68:71], v[100:103], v[156:159], v[68:71]
    buffer_load_dwordx4 v[144:147], v3, s[4:7], s39 offen offset:2048 sc1
    s_waitcnt lgkmcnt(6)
    v_mfma_f32_16x16x32_bf16 v[40:43], v[104:107], v[152:155], v[40:43]
    ds_read_b128 v[100:103], v5 offset:33792
    v_mfma_f32_16x16x32_bf16 v[72:75], v[104:107], v[156:159], v[72:75]
    s_waitcnt lgkmcnt(6)
    v_mfma_f32_16x16x32_bf16 v[44:47], v[108:111], v[152:155], v[44:47]
    ds_read_b128 v[104:107], v5 offset:34816
    v_mfma_f32_16x16x32_bf16 v[76:79], v[108:111], v[156:159], v[76:79]
    s_waitcnt lgkmcnt(6)
    v_mfma_f32_16x16x32_bf16 v[48:51], v[112:115], v[152:155], v[48:51]
    ds_read_b128 v[108:111], v5 offset:35840
    v_mfma_f32_16x16x32_bf16 v[80:83], v[112:115], v[156:159], v[80:83]
    s_waitcnt lgkmcnt(6)
    v_mfma_f32_16x16x32_bf16 v[52:55], v[116:119], v[152:155], v[52:55]
    ds_read_b128 v[112:115], v5 offset:36864
    v_mfma_f32_16x16x32_bf16 v[84:87], v[116:119], v[156:159], v[84:87]
    buffer_load_dwordx4 v[148:151], v4, s[4:7], s39 offen offset:2048 sc1
    s_waitcnt lgkmcnt(6)
    v_mfma_f32_16x16x32_bf16 v[56:59], v[120:123], v[152:155], v[56:59]
    ds_read_b128 v[116:119], v5 offset:37888
    v_mfma_f32_16x16x32_bf16 v[88:91], v[120:123], v[156:159], v[88:91]
    s_waitcnt lgkmcnt(6)
    v_mfma_f32_16x16x32_bf16 v[60:63], v[124:127], v[152:155], v[60:63]
    ds_read_b128 v[120:123], v5 offset:38912
    v_mfma_f32_16x16x32_bf16 v[92:95], v[124:127], v[156:159], v[92:95]
    s_waitcnt vmcnt(6)
    s_waitcnt lgkmcnt(6)
    v_mfma_f32_16x16x32_bf16 v[32:35], v[96:99], v[160:163], v[32:35]
    ds_read_b128 v[124:127], v5 offset:39936
    v_mfma_f32_16x16x32_bf16 v[64:67], v[96:99], v[164:167], v[64:67]
    v_add_u32 v5, 40960, v5
    s_waitcnt lgkmcnt(6)
    v_mfma_f32_16x16x32_bf16 v[36:39], v[100:103], v[160:163], v[36:39]
    ds_read_b128 v[96:99], v5 offset:0
    v_mfma_f32_16x16x32_bf16 v[68:71], v[100:103], v[164:167], v[68:71]
    buffer_load_dwordx4 v[152:155], v3, s[4:7], s39 offen offset:3072 sc1
    s_waitcnt lgkmcnt(6)
    v_mfma_f32_16x16x32_bf16 v[40:43], v[104:107], v[160:163], v[40:43]
    ds_read_b128 v[100:103], v5 offset:1024
    v_mfma_f32_16x16x32_bf16 v[72:75], v[104:107], v[164:167], v[72:75]
    s_add_u32 s38, s38, 5120
    s_waitcnt lgkmcnt(6)
    v_mfma_f32_16x16x32_bf16 v[44:47], v[108:111], v[160:163], v[44:47]
    ds_read_b128 v[104:107], v5 offset:2048
    v_mfma_f32_16x16x32_bf16 v[76:79], v[108:111], v[164:167], v[76:79]
    s_add_u32 s23, s23, 1
    s_waitcnt lgkmcnt(6)
    v_mfma_f32_16x16x32_bf16 v[48:51], v[112:115], v[160:163], v[48:51]
    ds_read_b128 v[108:111], v5 offset:3072
    v_mfma_f32_16x16x32_bf16 v[80:83], v[112:115], v[164:167], v[80:83]
    s_waitcnt lgkmcnt(6)
    v_mfma_f32_16x16x32_bf16 v[52:55], v[116:119], v[160:163], v[52:55]
    ds_read_b128 v[112:115], v5 offset:4096
    v_mfma_f32_16x16x32_bf16 v[84:87], v[116:119], v[164:167], v[84:87]
    buffer_load_dwordx4 v[156:159], v4, s[4:7], s39 offen offset:3072 sc1
    s_waitcnt lgkmcnt(6)
    v_mfma_f32_16x16x32_bf16 v[56:59], v[120:123], v[160:163], v[56:59]
    ds_read_b128 v[116:119], v5 offset:5120
    v_mfma_f32_16x16x32_bf16 v[88:91], v[120:123], v[164:167], v[88:91]
    s_add_u32 s39, s38, 1024
    s_cmp_eq_u32 s23, 3
    s_cselect_b32 s39, s29, s39
    s_waitcnt lgkmcnt(6)
    v_mfma_f32_16x16x32_bf16 v[60:63], v[124:127], v[160:163], v[60:63]
    ds_read_b128 v[120:123], v5 offset:6144
    v_mfma_f32_16x16x32_bf16 v[92:95], v[124:127], v[164:167], v[92:95]
    s_cmp_eq_u32 s23, 3
    s_cbranch_scc0 L_g1b_nb
    s_barrier
L_g1b_nb:
    s_cmp_lt_u32 s23, 4
    s_cbranch_scc1 L_g1b_loop
    s_waitcnt lgkmcnt(0)
    v_mov_b32 v106, 0
    v_mov_b32 v107, 0
    s_waitcnt vmcnt(6)
    v_pk_fma_f32 v[32:33], v[128:129], v[24:25], v[32:33] op_sel_hi:[1,0,1] neg_lo:[0,1,0] neg_hi:[0,1,0]
    v_pk_fma_f32 v[34:35], v[130:131], v[24:25], v[34:35] op_sel_hi:[1,0,1] neg_lo:[0,1,0] neg_hi:[0,1,0]
    v_pk_mul_f32 v[32:33], v[32:33], v[26:27] op_sel_hi:[1,0]
    v_pk_mul_f32 v[34:35], v[34:35], v[26:27] op_sel_hi:[1,0]
    v_cvt_pk_bf16_f32 v96, v32, v33
    v_cvt_pk_bf16_f32 v97, v34, v35
    v_pk_fma_f32 v[36:37], v[132:133], v[24:25], v[36:37] op_sel_hi:[1,0,1] neg_lo:[0,1,0] neg_hi:[0,1,0]
    v_pk_fma_f32 v[38:39], v[134:135], v[24:25], v[38:39] op_sel_hi:[1,0,1] neg_lo:[0,1,0] neg_hi:[0,1,0]
    v_pk_mul_f32 v[36:37], v[36:37], v[26:27] op_sel_hi:[1,0]
    v_pk_mul_f32 v[38:39], v[38:39], v[26:27] op_sel_hi:[1,0]
    v_cvt_pk_bf16_f32 v98, v36, v37
    v_cvt_pk_bf16_f32 v99, v38, v39
    ds_write_b128 v6, v[96:99] offset:0
    s_waitcnt vmcnt(4)
    v_pk_fma_f32 v[40:41], v[136:137], v[24:25], v[40:41] op_sel_hi:[1,0,1] neg_lo:[0,1,0] neg_hi:[0,1,0]
    v_pk_fma_f32 v[42:43], v[138:139], v[24:25], v[42:43] op_sel_hi:[1,0,1] neg_lo:[0,1,0] neg_hi:[0,1,0]
    v_pk_mul_f32 v[40:41], v[40:41], v[26:27] op_sel_hi:[1,0]
    v_pk_mul_f32 v[42:43], v[42:43], v[26:27] op_sel_hi:[1,0]
    v_cvt_pk_bf16_f32 v100, v40, v41
    v_cvt_pk_bf16_f32 v101, v42, v43
    v_pk_fma_f32 v[44:45], v[140:141], v[24:25], v[44:45] op_sel_hi:[1,0,1] neg_lo:[0,1,0] neg_hi:[0,1,0]
    v_pk_fma_f32 v[46:47], v[142:143], v[24:25], v[46:47] op_sel_hi:[1,0,1] neg_lo:[0,1,0] neg_hi:[0,1,0]
    v_pk_mul_f32 v[44:45], v[44:45], v[26:27] op_sel_hi:[1,0]
    v_pk_mul_f32 v[46:47], v[46:47], v[26:27] op_sel_hi:[1,0]
    v_cvt_pk_bf16_f32 v102, v44, v45
    v_cvt_pk_bf16_f32 v103, v46, v47
    ds_write_b128 v6, v[100:103] offset:16
    s_waitcnt vmcnt(2)
    v_pk_fma_f32 v[48:49], v[144:145], v[24:25], v[48:49] op_sel_hi:[1,0,1] neg_lo:[0,1,0] neg_hi:[0,1,0]
    v_pk_fma_f32 v[50:51], v[146:147], v[24:25], v[50:51] op_sel_hi:[1,0,1] neg_lo:[0,1,0] neg_hi:[0,1,0]
    v_pk_mul_f32 v[48:49], v[48:49], v[26:27] op_sel_hi:[1,0]
    v_pk_mul_f32 v[50:51], v[50:51], v[26:27] op_sel_hi:[1,0]
    v_cvt_pk_bf16_f32 v104, v48, v49
    v_cvt_pk_bf16_f32 v105, v50, v51
    ds_write_b128 v6, v[104:107] offset:32
    v_mov_b32 v118, 0
    v_mov_b32 v119, 0
    v_pk_fma_f32 v[64:65], v[128:129], v[28:29], v[64:65] op_sel_hi:[1,0,1] neg_lo:[0,1,0] neg_hi:[0,1,0]
    v_pk_fma_f32 v[66:67], v[130:131], v[28:29], v[66:67] op_sel_hi:[1,0,1] neg_lo:[0,1,0] neg_hi:[0,1,0]
    v_pk_mul_f32 v[64:65], v[64:65], v[30:31] op_sel_hi:[1,0]
    v_pk_mul_f32 v[66:67], v[66:67], v[30:31] op_sel_hi:[1,0]
    v_cvt_pk_bf16_f32 v108, v64, v65
    v_cvt_pk_bf16_f32 v109, v66, v67
    v_pk_fma_f32 v[68:69], v[132:133], v[28:29], v[68:69] op_sel_hi:[1,0,1] neg_lo:[0,1,0] neg_hi:[0,1,0]
    v_pk_fma_f32 v[70:71], v[134:135], v[28:29], v[70:71] op_sel_hi:[1,0,1] neg_lo:[0,1,0] neg_hi:[0,1,0]
    v_pk_mul_f32 v[68:69], v[68:69], v[30:31] op_sel_hi:[1,0]
    v_pk_mul_f32 v[70:71], v[70:71], v[30:31] op_sel_hi:[1,0]
    v_cvt_pk_bf16_f32 v110, v68, v69
    v_cvt_pk_bf16_f32 v111, v70, v71
    ds_write_b128 v6, v[108:111] offset:2816
    v_pk_fma_f32 v[72:73], v[136:137], v[28:29], v[72:73] op_sel_hi:[1,0,1] neg_lo:[0,1,0] neg_hi:[0,1,0]
    v_pk_fma_f32 v[74:75], v[138:139], v[28:29], v[74:75] op_sel_hi:[1,0,1] neg_lo:[0,1,0] neg_hi:[0,1,0]
    v_pk_mul_f32 v[72:73], v[72:73], v[30:31] op_sel_hi:[1,0]
    v_pk_mul_f32 v[74:75], v[74:75], v[30:31] op_sel_hi:[1,0]
    v_cvt_pk_bf16_f32 v112, v72, v73
    v_cvt_pk_bf16_f32 v113, v74, v75
    v_pk_fma_f32 v[76:77], v[140:141], v[28:29], v[76:77] op_sel_hi:[1,0,1] neg_lo:[0,1,0] neg_hi:[0,1,0]
    v_pk_fma_f32 v[78:79], v[142:143], v[28:29], v[78:79] op_sel_hi:[1,0,1] neg_lo:[0,1,0] neg_hi:[0,1,0]
    v_pk_mul_f32 v[76:77], v[76:77], v[30:31] op_sel_hi:[1,0]
    v_pk_mul_f32 v[78:79], v[78:79], v[30:31] op_sel_hi:[1,0]
    v_cvt_pk_bf16_f32 v114, v76, v77
    v_cvt_pk_bf16_f32 v115, v78, v79
    ds_write_b128 v6, v[112:115] offset:2832
    v_pk_fma_f32 v[80:81], v[144:145], v[28:29], v[80:81] op_sel_hi:[1,0,1] neg_lo:[0,1,0] neg_hi:[0,1,0]
    v_pk_fma_f32 v[82:83], v[146:147], v[28:29], v[82:83] op_sel_hi:[1,0,1] neg_lo:[0,1,0] neg_hi:[0,1,0]
    v_pk_mul_f32 v[80:81], v[80:81], v[30:31] op_sel_hi:[1,0]
    v_pk_mul_f32 v[82:83], v[82:83], v[30:31] op_sel_hi:[1,0]
    v_cvt_pk_bf16_f32 v116, v80, v81
    v_cvt_pk_bf16_f32 v117, v82, v83
    ds_write_b128 v6, v[116:119] offset:2848
    v_mov_b32 v26, v25
    v_mov_b32 v30, v29
    s_waitcnt vmcnt(0)
    v_pk_fma_f32 v[52:53], v[148:149], v[24:25], v[52:53] op_sel_hi:[1,0,1] neg_lo:[0,1,0] neg_hi:[0,1,0]
    v_pk_fma_f32 v[54:55], v[150:151], v[24:25], v[54:55] op_sel_hi:[1,0,1] neg_lo:[0,1,0] neg_hi:[0,1,0]
    v_pk_mul_f32 v[52:53], v[52:53], v[26:27] op_sel_hi:[1,0]
    v_pk_mul_f32 v[54:55], v[54:55], v[26:27] op_sel_hi:[1,0]
    v_cvt_pk_bf16_f32 v52, v52, v53
    v_cvt_pk_bf16_f32 v53, v54, v55
    ds_write_b64 v8, v[52:53] offset:192
    v_pk_fma_f32 v[84:85], v[148:149], v[28:29], v[84:85] op_sel_hi:[1,0,1] neg_lo:[0,1,0] neg_hi:[0,1,0]
    v_pk_fma_f32 v[86:87], v[150:151], v[28:29], v[86:87] op_sel_hi:[1,0,1] neg_lo:[0,1,0] neg_hi:[0,1,0]
    v_pk_mul_f32 v[84:85], v[84:85], v[30:31] op_sel_hi:[1,0]
    v_pk_mul_f32 v[86:87], v[86:87], v[30:31] op_sel_hi:[1,0]
    v_cvt_pk_bf16_f32 v84, v84, v85
    v_cvt_pk_bf16_f32 v85, v86, v87
    ds_write_b64 v8, v[84:85] offset:3008
    v_pk_fma_f32 v[56:57], v[152:153], v[24:25], v[56:57] op_sel_hi:[1,0,1] neg_lo:[0,1,0] neg_hi:[0,1,0]
    v_pk_fma_f32 v[58:59], v[154:155], v[24:25], v[58:59] op_sel_hi:[1,0,1] neg_lo:[0,1,0] neg_hi:[0,1,0]
    v_pk_mul_f32 v[56:57], v[56:57], v[26:27] op_sel_hi:[1,0]
    v_pk_mul_f32 v[58:59], v[58:59], v[26:27] op_sel_hi:[1,0]
    v_cvt_pk_bf16_f32 v56, v56, v57
    v_cvt_pk_bf16_f32 v57, v58, v59
    ds_write_b64 v9, v[56:57] offset:192
    v_pk_fma_f32 v[88:89], v[152:153], v[28:29], v[88:89] op_sel_hi:[1,0,1] neg_lo:[0,1,0] neg_hi:[0,1,0]
    v_pk_fma_f32 v[90:91], v[154:155], v[28:29], v[90:91] op_sel_hi:[1,0,1] neg_lo:[0,1,0] neg_hi:[0,1,0]
    v_pk_mul_f32 v[88:89], v[88:89], v[30:31] op_sel_hi:[1,0]
    v_pk_mul_f32 v[90:91], v[90:91], v[30:31] op_sel_hi:[1,0]
    v_cvt_pk_bf16_f32 v88, v88, v89
    v_cvt_pk_bf16_f32 v89, v90, v91
    ds_write_b64 v9, v[88:89] offset:3008
    v_pk_fma_f32 v[60:61], v[156:157], v[24:25], v[60:61] op_sel_hi:[1,0,1] neg_lo:[0,1,0] neg_hi:[0,1,0]
    v_pk_fma_f32 v[62:63], v[158:159], v[24:25], v[62:63] op_sel_hi:[1,0,1] neg_lo:[0,1,0] neg_hi:[0,1,0]
    v_pk_mul_f32 v[60:61], v[60:61], v[26:27] op_sel_hi:[1,0]
    v_pk_mul_f32 v[62:63], v[62:63], v[26:27] op_sel_hi:[1,0]
    v_cvt_pk_bf16_f32 v60, v60, v61
    v_cvt_pk_bf16_f32 v61, v62, v63
    s_mov_b32 exec_lo, 0
    v_mov_b32 v60, 0x3f80
    v_mov_b32 v61, 0
    ds_write_b64 v10, v[60:61] offset:208
    s_mov_b32 exec_lo, -1
    ds_write_b64 v10, v[60:61] offset:192
    v_pk_fma_f32 v[92:93], v[156:157], v[28:29], v[92:93] op_sel_hi:[1,0,1] neg_lo:[0,1,0] neg_hi:[0,1,0]
    v_pk_fma_f32 v[94:95], v[158:159], v[28:29], v[94:95] op_sel_hi:[1,0,1] neg_lo:[0,1,0] neg_hi:[0,1,0]
    v_pk_mul_f32 v[92:93], v[92:93], v[30:31] op_sel_hi:[1,0]
    v_pk_mul_f32 v[94:95], v[94:95], v[30:31] op_sel_hi:[1,0]
    v_cvt_pk_bf16_f32 v92, v92, v93
    v_cvt_pk_bf16_f32 v93, v94, v95
    s_mov_b32 exec_lo, 0
    v_mov_b32 v92, 0x3f80
    v_mov_b32 v93, 0
    ds_write_b64 v10, v[92:93] offset:3024
    s_mov_b32 exec_lo, -1
    ds_write_b64 v10, v[92:93] offset:3008
    s_branch L_g1b_la
L_g1b_halo:
    s_sub_u32 s36, s36, 1
    s_max_i32 s36, s36, 0
    s_sub_u32 s37, s3, 4
    s_mul_i32 s42, s36, 20480
    s_add_u32 s42, s42, s41
    s_lshl_b32 s28, s36, 10
    s_add_u32 s33, s33, s28
    s_lshl_b32 s28, s37, 10
    s_add_u32 s29, s29, s28
    s_lshl_b32 s28, s37, 11
    v_add_u32 v5, s28, v3
    v_add_u32 v16, 65536, v5
    v_add_u32 v17, 131072, v5
    s_mov_b32 s28, 0
    v_and_b32 v13, 1, v1
    v_mul_u32_u24 v12, 25360, v13
    v_lshrrev_b32 v13, 1, v1
    v_mul_u32_u24 v13, 352, v13
    v_add3_u32 v12, v12, v13, s28
    v_mad_u32_u24 v6, v2, 48, v12
    s_lshl_b32 s28, s37, 4
    v_add_u32 v6, s28, v6
    s_lshl_b32 s28, s37, 3
    s_sub_u32 s28, s28, 20
    s_add_u32 s30, s28, 4
    v_add_u32 v13, s28, v2
    v_cmp_le_u32 vcc, 5, v13
    v_cmp_eq_u32 s[24:25], 10, v13
    v_lshl_add_u32 v8, v13, 3, v12
    v_cmp_eq_u32 s[26:27], 11, v13
    v_cndmask_b32 v13, 0, 24, vcc
    v_cndmask_b32 v13, v13, -8, s[24:25]
    v_cndmask_b32 v13, v13, 48, s[26:27]
    v_add3_u32 v8, v8, v13, 0
    v_subrev_u32 v13, 32, v8
    v_cndmask_b32 v8, v8, v13, s[24:25]
    v_cndmask_b32 v8, v8, v13, s[26:27]
    v_add_u32 v13, s30, v2
    v_cmp_le_u32 vcc, 5, v13
    v_cmp_eq_u32 s[24:25], 10, v13
    v_lshl_add_u32 v9, v13, 3, v12
    v_cmp_eq_u32 s[26:27], 11, v13
    v_cndmask_b32 v13, 0, 24, vcc
    v_cndmask_b32 v13, v13, -8, s[24:25]
    v_cndmask_b32 v13, v13, 48, s[26:27]
    v_add3_u32 v9, v9, v13, 0
    v_subrev_u32 v13, 32, v9
    v_cndmask_b32 v9, v9, v13, s[24:25]
    v_cndmask_b32 v9, v9, v13, s[26:27]
    s_add_u32 s43, s42, 4096
    s_add_u32 s44, s42, 8192
    s_add_u32 s45, s42, 12288
    s_add_u32 s46, s42, 16384
    s_setprio 0
    s_barrier
    buffer_load_dwordx2 v[24:25], v11, s[4:7], s33 offen offset:0 sc1
    buffer_load_dwordx2 v[26:27], v11, s[4:7], s33 offen offset:128 sc1
    buffer_load_dwordx4 v[128:131], v3, s[4:7], s29 offen sc1
    buffer_load_dwordx4 v[132:135], v4, s[4:7], s29 offen sc1
    buffer_load_dwordx4 v[40:43], v3, s[4:7], s42 offen offset:0 sc1
    buffer_load_dwordx4 v[44:47], v3, s[4:7], s42 offen offset:1024 sc1
    buffer_load_dwordx4 v[48:51], v3, s[4:7], s42 offen offset:2048 sc1
    buffer_load_dwordx4 v[52:55], v3, s[4:7], s42 offen offset:3072 sc1
    buffer_load_dwordx4 v[56:59], v3, s[4:7], s43 offen offset:0 sc1
    buffer_load_dwordx4 v[60:63], v3, s[4:7], s43 offen offset:1024 sc1
    ds_read_b128 v[96:99], v16 offset:57344
    ds_read_b128 v[100:103], v16 offset:58368
    ds_read_b128 v[104:107], v17 offset:0
    ds_read_b128 v[108:111], v17 offset:1024
    s_waitcnt vmcnt(5) lgkmcnt(2)
    v_mfma_f32_16x16x32_bf16 v[32:35], v[96:99], v[40:43], 0
    v_mfma_f32_16x16x32_bf16 v[36:39], v[100:103], v[40:43], 0
    buffer_load_dwordx4 v[40:43], v3, s[4:7], s43 offen offset:2048 sc1
    ds_read_b128 v[112:115], v17 offset:8192
    ds_read_b128 v[116:119], v17 offset:9216
    s_waitcnt vmcnt(5) lgkmcnt(2)
    v_mfma_f32_16x16x32_bf16 v[32:35], v[104:107], v[44:47], v[32:35]
    v_mfma_f32_16x16x32_bf16 v[36:39], v[108:111], v[44:47], v[36:39]
    buffer_load_dwordx4 v[44:47], v3, s[4:7], s43 offen offset:3072 sc1
    ds_read_b128 v[120:123], v17 offset:16384
    ds_read_b128 v[124:127], v17 offset:17408
    s_waitcnt vmcnt(5) lgkmcnt(2)
    v_mfma_f32_16x16x32_bf16 v[32:35], v[112:115], v[48:51], v[32:35]
    v_mfma_f32_16x16x32_bf16 v[36:39], v[116:119], v[48:51], v[36:39]
    buffer_load_dwordx4 v[48:51], v3, s[4:7], s44 offen offset:0 sc1
    ds_read_b128 v[96:99], v17 offset:24576
    ds_read_b128 v[100:103], v17 offset:25600
    s_waitcnt vmcnt(5) lgkmcnt(2)
    v_mfma_f32_16x16x32_bf16 v[32:35], v[120:123], v[52:55], v[32:35]
    v_mfma_f32_16x16x32_bf16 v[36:39], v[124:127], v[52:55], v[36:39]
    buffer_load_dwordx4 v[52:55], v3, s[4:7], s44 offen offset:1024 sc1
    ds_read_b128 v[104:107], v5 offset:0
    ds_read_b128 v[108:111], v5 offset:1024
    s_waitcnt vmcnt(5) lgkmcnt(2)
    v_mfma_f32_16x16x32_bf16 v[32:35], v[96:99], v[56:59], v[32:35]
    v_mfma_f32_16x16x32_bf16 v[36:39], v[100:103], v[56:59], v[36:39]
    buffer_load_dwordx4 v[56:59], v3, s[4:7], s44 offen offset:2048 sc1
    ds_read_b128 v[112:115], v5 offset:8192
    ds_read_b128 v[116:119], v5 offset:9216
    s_waitcnt vmcnt(5) lgkmcnt(2)
    v_mfma_f32_16x16x32_bf16 v[32:35], v[104:107], v[60:63], v[32:35]
    v_mfma_f32_16x16x32_bf16 v[36:39], v[108:111], v[60:63], v[36:39]
    buffer_load_dwordx4 v[60:63], v3, s[4:7], s44 offen offset:3072 sc1
    s_barrier
    ds_read_b128 v[120:123], v5 offset:16384
    ds_read_b128 v[124:127], v5 offset:17408
    s_waitcnt vmcnt(5) lgkmcnt(2)
    v_mfma_f32_16x16x32_bf16 v[32:35], v[112:115], v[40:43], v[32:35]
    v_mfma_f32_16x16x32_bf16 v[36:39], v[116:119], v[40:43], v[36:39]
    buffer_load_dwordx4 v[40:43], v3, s[4:7], s45 offen offset:0 sc1
    ds_read_b128 v[96:99], v5 offset:24576
    ds_read_b128 v[100:103], v5 offset:25600
    s_waitcnt vmcnt(5) lgkmcnt(2)
    v_mfma_f32_16x16x32_bf16 v[32:35], v[120:123], v[44:47], v[32:35]
    v_mfma_f32_16x16x32_bf16 v[36:39], v[124:127], v[44:47], v[36:39]
    buffer_load_dwordx4 v[44:47], v3, s[4:7], s45 offen offset:1024 sc1
    ds_read_b128 v[104:107], v5 offset:32768
    ds_read_b128 v[108:111], v5 offset:33792
    s_waitcnt vmcnt(5) lgkmcnt(2)
    v_mfma_f32_16x16x32_bf16 v[32:35], v[96:99], v[48:51], v[32:35]
    v_mfma_f32_16x16x32_bf16 v[36:39], v[100:103], v[48:51], v[36:39]
    buffer_load_dwordx4 v[48:51], v3, s[4:7], s45 offen offset:2048 sc1
    ds_read_b128 v[112:115], v5 offset:40960
    ds_read_b128 v[116:119], v5 offset:41984
    s_waitcnt vmcnt(5) lgkmcnt(2)
    v_mfma_f32_16x16x32_bf16 v[32:35], v[104:107], v[52:55], v[32:35]
    v_mfma_f32_16x16x32_bf16 v[36:39], v[108:111], v[52:55], v[36:39]
    buffer_load_dwordx4 v[52:55], v3, s[4:7], s45 offen offset:3072 sc1
    v_pk_add_f32 v[24:25], v[24:25], v[26:27]
    v_mov_b32 v26, v24
    v_mov_b32 v27, v25
    s_nop 1
    v_permlane32_swap_b32 v24, v26
    v_permlane32_swap_b32 v25, v27
    s_nop 1
    v_add_f32 v24, v24, v26
    v_add_f32 v25, v25, v27
    v_mov_b32 v26, v24
    v_mov_b32 v27, v25
    s_nop 1
    v_permlane16_swap_b32 v24, v26
    v_permlane16_swap_b32 v25, v27
    s_nop 1
    v_add_f32 v24, v24, v26
    v_add_f32 v25, v25, v27
    v_mul_f32 v24, 0x3acccccd, v24
    v_mul_f32 v25, 0x3acccccd, v25
    v_fma_f32 v25, -v24, v24, v25
    v_max_f32 v25, 0, v25
    v_add_f32 v25, 0x3727c5ac, v25
    v_rsq_f32 v25, v25
    s_nop 0
    v_mul_f32 v26, 1.0, v25
    ds_read_b128 v[120:123], v5 offset:49152
    ds_read_b128 v[124:127], v5 offset:50176
    s_waitcnt vmcnt(5) lgkmcnt(2)
    v_mfma_f32_16x16x32_bf16 v[32:35], v[112:115], v[56:59], v[32:35]
    v_mfma_f32_16x16x32_bf16 v[36:39], v[116:119], v[56:59], v[36:39]
    buffer_load_dwordx4 v[56:59], v3, s[4:7], s46 offen offset:0 sc1
    ds_read_b128 v[96:99], v5 offset:57344
    ds_read_b128 v[100:103], v5 offset:58368
    s_waitcnt vmcnt(5) lgkmcnt(2)
    v_mfma_f32_16x16x32_bf16 v[32:35], v[120:123], v[60:63], v[32:35]
    v_mfma_f32_16x16x32_bf16 v[36:39], v[124:127], v[60:63], v[36:39]
    buffer_load_dwordx4 v[60:63], v3, s[4:7], s46 offen offset:1024 sc1
    ds_read_b128 v[104:107], v16 offset:0
    ds_read_b128 v[108:111], v16 offset:1024
    s_waitcnt vmcnt(5) lgkmcnt(2)
    v_mfma_f32_16x16x32_bf16 v[32:35], v[96:99], v[40:43], v[32:35]
    v_mfma_f32_16x16x32_bf16 v[36:39], v[100:103], v[40:43], v[36:39]
    buffer_load_dwordx4 v[40:43], v3, s[4:7], s46 offen offset:2048 sc1
    ds_read_b128 v[112:115], v16 offset:8192
    ds_read_b128 v[116:119], v16 offset:9216
    s_waitcnt vmcnt(5) lgkmcnt(2)
    v_mfma_f32_16x16x32_bf16 v[32:35], v[104:107], v[44:47], v[32:35]
    v_mfma_f32_16x16x32_bf16 v[36:39], v[108:111], v[44:47], v[36:39]
    buffer_load_dwordx4 v[44:47], v3, s[4:7], s46 offen offset:3072 sc1
    ds_read_b128 v[120:123], v16 offset:16384
    ds_read_b128 v[124:127], v16 offset:17408
    s_waitcnt vmcnt(5) lgkmcnt(2)
    v_mfma_f32_16x16x32_bf16 v[32:35], v[112:115], v[48:51], v[32:35]
    v_mfma_f32_16x16x32_bf16 v[36:39], v[116:119], v[48:51], v[36:39]
    s_barrier
    ds_read_b128 v[96:99], v16 offset:24576
    ds_read_b128 v[100:103], v16 offset:25600
    s_waitcnt vmcnt(4) lgkmcnt(2)
    v_mfma_f32_16x16x32_bf16 v[32:35], v[120:123], v[52:55], v[32:35]
    v_mfma_f32_16x16x32_bf16 v[36:39], v[124:127], v[52:55], v[36:39]
    ds_read_b128 v[104:107], v16 offset:32768
    ds_read_b128 v[108:111], v16 offset:33792
    s_waitcnt vmcnt(3) lgkmcnt(2)
    v_mfma_f32_16x16x32_bf16 v[32:35], v[96:99], v[56:59], v[32:35]
    v_mfma_f32_16x16x32_bf16 v[36:39], v[100:103], v[56:59], v[36:39]
    ds_read_b128 v[112:115], v16 offset:40960
    ds_read_b128 v[116:119], v16 offset:41984
    s_waitcnt vmcnt(2) lgkmcnt(2)
    v_mfma_f32_16x16x32_bf16 v[32:35], v[104:107], v[60:63], v[32:35]
    v_mfma_f32_16x16x32_bf16 v[36:39], v[108:111], v[60:63], v[36:39]
    ds_read_b128 v[120:123], v16 offset:49152
    ds_read_b128 v[124:127], v16 offset:50176
    s_waitcnt vmcnt(1) lgkmcnt(2)
    v_mfma_f32_16x16x32_bf16 v[32:35], v[112:115], v[40:43], v[32:35]
    v_mfma_f32_16x16x32_bf16 v[36:39], v[116:119], v[40:43], v[36:39]
    s_waitcnt vmcnt(0) lgkmcnt(0)
    v_mfma_f32_16x16x32_bf16 v[32:35], v[120:123], v[44:47], v[32:35]
    v_mfma_f32_16x16x32_bf16 v[36:39], v[124:127], v[44:47], v[36:39]
    s_waitcnt vmcnt(0)
    s_setprio 2
    s_nop 5
    v_pk_fma_f32 v[32:33], v[128:129], v[24:25], v[32:33] op_sel_hi:[1,0,1] neg_lo:[0,1,0] neg_hi:[0,1,0]
    v_pk_fma_f32 v[34:35], v[130:131], v[24:25], v[34:35] op_sel_hi:[1,0,1] neg_lo:[0,1,0] neg_hi:[0,1,0]
    v_pk_mul_f32 v[32:33], v[32:33], v[26:27] op_sel_hi:[1,0]
    v_pk_mul_f32 v[34:35], v[34:35], v[26:27] op_sel_hi:[1,0]
    s_cmp_ge_u32 s37, 3
    s_cbranch_scc1 L_g1b_hv0
    v_cvt_pk_bf16_f32 v32, v32, v33
    v_cvt_pk_bf16_f32 v33, v34, v35
    ds_write_b64 v6, v[32:33] offset:0
    s_branch L_g1b_hd0
L_g1b_hv0:
    v_cvt_pk_bf16_f32 v32, v32, v33
    v_cvt_pk_bf16_f32 v33, v34, v35
    ds_write_b64 v8, v[32:33] offset:192
L_g1b_hd0:
    v_pk_fma_f32 v[36:37], v[132:133], v[24:25], v[36:37] op_sel_hi:[1,0,1] neg_lo:[0,1,0] neg_hi:[0,1,0]
    v_pk_fma_f32 v[38:39], v[134:135], v[24:25], v[38:39] op_sel_hi:[1,0,1] neg_lo:[0,1,0] neg_hi:[0,1,0]
    v_pk_mul_f32 v[36:37], v[36:37], v[26:27] op_sel_hi:[1,0]
    v_pk_mul_f32 v[38:39], v[38:39], v[26:27] op_sel_hi:[1,0]
    s_cmp_ge_u32 s37, 2
    s_cbranch_scc1 L_g1b_hv1
    v_cvt_pk_bf16_f32 v36, v36, v37
    v_cvt_pk_bf16_f32 v37, v38, v39
    ds_write_b64 v6, v[36:37] offset:8
    s_branch L_g1b_hd1
L_g1b_hv1:
    s_cmp_eq_u32 s37, 3
    s_cbranch_scc1 L_g1b_hl
    v_cvt_pk_bf16_f32 v36, v36, v37
    v_cvt_pk_bf16_f32 v37, v38, v39
    ds_write_b64 v9, v[36:37] offset:192
    s_branch L_g1b_hd1
L_g1b_hl:
    v_cvt_pk_bf16_f32 v36, v36, v37
    v_cvt_pk_bf16_f32 v37, v38, v39
    s_mov_b32 exec_lo, 0
    v_mov_b32 v36, 0x3f80
    v_mov_b32 v37, 0
    ds_write_b64 v9, v[36:37] offset:208
    s_mov_b32 exec_lo, -1
    ds_write_b64 v9, v[36:37] offset:192
L_g1b_hd1:
L_g1b_la:
    s_waitcnt lgkmcnt(0)
    v_mov_b64 v[44:45], 0
    v_mov_b64 v[46:47], 0
    v_mov_b64 v[48:49], 0
    v_mov_b64 v[50:51], 0
    s_mov_b32 exec_hi, 0xffff
    s_barrier
    ds_read_b128 v[44:47], v7 offset:0
    ds_read_b128 v[48:51], v7 offset:25360
    s_mov_b32 exec_hi, -1
    ds_read_b128 v[52:55], v18 offset:96
    ds_read_b128 v[56:59], v7 offset:96
    ds_read_b128 v[60:63], v18 offset:25456
    ds_read_b128 v[64:67], v7 offset:25456
    ds_read_b64_tr_b16 v[68:69], v20 offset:192
    ds_read_b64_tr_b16 v[70:71], v19 offset:192
    ds_read_b64_tr_b16 v[72:73], v20 offset:224
    ds_read_b64_tr_b16 v[74:75], v19 offset:224
    ds_read_b64_tr_b16 v[76:77], v20 offset:25552
    ds_read_b64_tr_b16 v[78:79], v19 offset:25552
    ds_read_b64_tr_b16 v[80:81], v20 offset:25584
    ds_read_b64_tr_b16 v[82:83], v19 offset:25584
    v_mov_b32 v32, 0xceabfb8f
    v_cndmask_b32 v40, v32, 0, s[48:49]
    v_cndmask_b32 v41, v32, 0, s[50:51]
    v_cndmask_b32 v42, v32, 0, s[52:53]
    v_cndmask_b32 v43, v32, 0, s[54:55]
    v_cndmask_b32 v36, v32, 0, s[8:9]
    v_cndmask_b32 v37, v32, 0, s[10:11]
    v_cndmask_b32 v38, v32, 0, s[12:13]
    v_cndmask_b32 v39, v32, 0, s[14:15]
    s_waitcnt lgkmcnt(10)
    v_mfma_f32_16x16x32_bf16 v[84:87], v[52:55], v[44:47], v[40:43]
    v_mfma_f32_16x16x32_bf16 v[88:91], v[56:59], v[44:47], v[36:39]
    s_waitcnt lgkmcnt(8)
    v_mfma_f32_16x16x32_bf16 v[92:95], v[60:63], v[48:51], v[40:43]
    v_mfma_f32_16x16x32_bf16 v[96:99], v[64:67], v[48:51], v[36:39]
    s_nop 4
    v_max3_f32 v24, v84, v85, v86
    v_max3_f32 v28, v87, v88, v89
    v_max3_f32 v24, v24, v90, v91
    v_max3_f32 v26, v92, v93, v94
    v_max3_f32 v30, v95, v96, v97
    v_max3_f32 v26, v26, v98, v99
    v_max_f32 v24, v24, v28
    v_max_f32 v26, v26, v30
    v_mov_b32 v28, v24
    v_mov_b32 v30, v26
    s_nop 0
    v_permlane32_swap_b32 v24, v28
    v_permlane32_swap_b32 v26, v30
    v_max_f32 v24, v24, v28
    v_max_f32 v26, v26, v30
    v_mov_b32 v28, v24
    v_mov_b32 v30, v26
    s_nop 0
    v_permlane16_swap_b32 v24, v28
    v_permlane16_swap_b32 v26, v30
    v_max_f32 v24, v24, v28
    v_max_f32 v26, v26, v30
    v_pk_add_f32 v[84:85], v[84:85], v[24:25] op_sel_hi:[1,0] neg_lo:[0,1] neg_hi:[0,1]
    v_pk_add_f32 v[86:87], v[86:87], v[24:25] op_sel_hi:[1,0] neg_lo:[0,1] neg_hi:[0,1]
    v_pk_add_f32 v[88:89], v[88:89], v[24:25] op_sel_hi:[1,0] neg_lo:[0,1] neg_hi:[0,1]
    v_pk_add_f32 v[90:91], v[90:91], v[24:25] op_sel_hi:[1,0] neg_lo:[0,1] neg_hi:[0,1]
    v_pk_add_f32 v[92:93], v[92:93], v[26:27] op_sel_hi:[1,0] neg_lo:[0,1] neg_hi:[0,1]
    v_pk_add_f32 v[94:95], v[94:95], v[26:27] op_sel_hi:[1,0] neg_lo:[0,1] neg_hi:[0,1]
    v_pk_add_f32 v[96:97], v[96:97], v[26:27] op_sel_hi:[1,0] neg_lo:[0,1] neg_hi:[0,1]
    v_pk_add_f32 v[98:99], v[98:99], v[26:27] op_sel_hi:[1,0] neg_lo:[0,1] neg_hi:[0,1]
    v_exp_f32 v84, v84
    v_exp_f32 v85, v85
    v_exp_f32 v86, v86
    v_exp_f32 v87, v87
    v_exp_f32 v88, v88
    v_exp_f32 v89, v89
    v_exp_f32 v90, v90
    v_exp_f32 v91, v91
    v_exp_f32 v92, v92
    v_cvt_pk_bf16_f32 v100, v84, v85
    v_exp_f32 v93, v93
    v_cvt_pk_bf16_f32 v101, v86, v87
    v_exp_f32 v94, v94
    v_cvt_pk_bf16_f32 v102, v88, v89
    v_exp_f32 v95, v95
    v_cvt_pk_bf16_f32 v103, v90, v91
    v_exp_f32 v96, v96
    v_exp_f32 v97, v97
    s_waitcnt lgkmcnt(0)
    v_mfma_f32_16x16x32_bf16 v[112:115], v[72:75], v[100:103], 0
    v_exp_f32 v98, v98
    v_exp_f32 v99, v99
    v_mfma_f32_16x16x32_bf16 v[108:111], v[68:71], v[100:103], 0
    v_cvt_pk_bf16_f32 v104, v92, v93
    v_cvt_pk_bf16_f32 v105, v94, v95
    v_cvt_pk_bf16_f32 v106, v96, v97
    v_cvt_pk_bf16_f32 v107, v98, v99
    s_nop 0
    v_mov_b32 v24, v112
    v_mov_b32 v28, v112
    v_mfma_f32_16x16x32_bf16 v[120:123], v[80:83], v[104:107], 0
    v_mfma_f32_16x16x32_bf16 v[116:119], v[76:79], v[104:107], 0
    v_permlane16_swap_b32 v24, v28
    s_nop 0
    v_rcp_f32 v28, v28
    s_nop 0
    v_pk_mul_f32 v[112:113], v[112:113], v[28:29] op_sel_hi:[1,0]
    v_pk_mul_f32 v[114:115], v[114:115], v[28:29] op_sel_hi:[1,0]
    v_pk_mul_f32 v[108:109], v[108:109], v[28:29] op_sel_hi:[1,0]
    v_pk_mul_f32 v[110:111], v[110:111], v[28:29] op_sel_hi:[1,0]
    v_mov_b32 v26, v120
    v_mov_b32 v30, v120
    v_cvt_pk_bf16_f32 v124, v108, v109
    v_cvt_pk_bf16_f32 v128, v112, v113
    v_permlane16_swap_b32 v26, v30
    v_cvt_pk_bf16_f32 v125, v110, v111
    v_cvt_pk_bf16_f32 v129, v114, v115
    v_rcp_f32 v30, v30
    s_nop 0
    v_pk_mul_f32 v[116:117], v[116:117], v[30:31] op_sel_hi:[1,0]
    v_pk_mul_f32 v[118:119], v[118:119], v[30:31] op_sel_hi:[1,0]
    v_pk_mul_f32 v[120:121], v[120:121], v[30:31] op_sel_hi:[1,0]
    v_pk_mul_f32 v[122:123], v[122:123], v[30:31] op_sel_hi:[1,0]
    v_cvt_pk_bf16_f32 v126, v116, v117
    v_cvt_pk_bf16_f32 v127, v118, v119
    v_cvt_pk_bf16_f32 v130, v120, v121
    v_cvt_pk_bf16_f32 v131, v122, v123
    v_permlane16_swap_b32 v124, v126
    v_permlane16_swap_b32 v125, v127
    v_permlane16_swap_b32 v128, v130
    buffer_store_dwordx4 v[124:127], v22, s[4:7], s35 offen sc1
    v_permlane16_swap_b32 v129, v131
    s_mov_b32 exec_hi, 0
    buffer_store_dwordx2 v[128:129], v21, s[4:7], s31 offen sc1
    s_mov_b32 exec_hi, -1
    s_lshl_b32 s60, s34, 7
    v_mul_u32_u24 v24, 139264, v0
    v_add_u32 v24, s60, v24
    v_mov_b32 v26, 1
    s_waitcnt vmcnt(0)
    s_mov_b64 exec, 1
    buffer_atomic_add v26, v24, s[4:7], 0 offen sc1
    s_mov_b64 exec, -1
    s_branch L_g2
L_fin:
    s_endpgm
L_exit:
    s_endpgm
L_code_end:
.section .rodata,"a"
.p2align 6
.amdhsa_kernel interleave_layers__softmax_full_mha__sliding_local_dilated__prompt_kernel
  .amdhsa_next_free_vgpr 168
  .amdhsa_next_free_sgpr 102
  .amdhsa_accum_offset 168
  .amdhsa_group_segment_fixed_size 0
  .amdhsa_kernarg_size 72
  .amdhsa_user_sgpr_count 2
  .amdhsa_user_sgpr_kernarg_segment_ptr 1
  .amdhsa_system_sgpr_workgroup_id_x 1
.end_amdhsa_kernel
```
